```python
import torch

def _softmax(x, axis=-1):
    return torch.softmax(x, dim=axis)
def _gelu(x):
    return torch.nn.functional.gelu(x, approximate="tanh")
def _silu(x):
    return torch.nn.functional.silu(x)
def _sigmoid(x):
    return torch.sigmoid(x)
def _layernorm(x, axis=-1, eps=1e-5):
    m = x.mean(dim=axis, keepdim=True)
    v = x.var(dim=axis, keepdim=True, unbiased=False)
    return (x - m) / torch.sqrt(v + eps)
def _scatter_add(tgt, idx, src, axis=0):
    return tgt.clone().index_add_(axis, idx, src)
def _segment_sum(src, seg, n):
    out = torch.zeros((n,) + src.shape[1:], dtype=src.dtype)
    return out.index_add_(0, seg, src)
def _pad(x, pw):
    flat = tuple(v for pair in reversed(pw) for v in pair)
    return torch.nn.functional.pad(x, flat)

kernel_name = 'sequential_preLN__mha_block_cached__mixer_token_mlp__decode'

def setup_inputs():

    _w = (lambda a: (lambda t: t.to(torch.bfloat16) if t.is_floating_point() else t)(torch.as_tensor(a)))
    def _A_setup():
        B, Sq, D = 2, 1, 640
        H, Sk, Dh = 32, 8192, 128
        return {
            "x": _w((lambda *s: torch.randn(*s, dtype=torch.bfloat16) * 0.05)(B, Sq, D)),
            "k_cache": _w((lambda *s: torch.randn(*s, dtype=torch.bfloat16) * 3.2)(B, H, Sk, Dh)),
            "v_cache": _w((lambda *s: torch.randn(*s, dtype=torch.bfloat16) * 0.8)(B, H, Sk, Dh)),
            "wq": _w((lambda *s: torch.randn(*s, dtype=torch.bfloat16) * 3.2)(D, H * Dh) * (D ** -0.5)),
            "wo": _w((lambda *s: torch.randn(*s, dtype=torch.bfloat16) * 0.8)(H * Dh, D) * ((H * Dh) ** -0.5)),
        }
    _A_in = _A_setup()

    def _B_setup():
        B, S, D, F = 2, 1, 640, 1728
        return {
            "x": _w((lambda *s: torch.randn(*s, dtype=torch.bfloat16) * 0.05)(B, S, D)),
            "w1": _w((lambda *s: torch.randn(*s, dtype=torch.bfloat16) * 1.6)(S, F) * (S ** -0.5)),
            "b1": _w((lambda *s: torch.randn(*s, dtype=torch.bfloat16) * 1.6)(F) * 0.02),
            "w2": _w((lambda *s: torch.randn(*s, dtype=torch.bfloat16) * 1.6)(F, S) * (F ** -0.5)),
            "b2": _w((lambda *s: torch.randn(*s, dtype=torch.bfloat16) * 0.8)(S) * 0.02),
        }
    _B_in = _B_setup()

    return {
        "A_x": _A_in["x"],
        "A_k_cache": _A_in["k_cache"],
        "A_v_cache": _A_in["v_cache"],
        "A_wq": _A_in["wq"],
        "A_wo": _A_in["wo"],
        "B_x": _B_in["x"],
        "B_w1": _B_in["w1"],
        "B_b1": _B_in["b1"],
        "B_w2": _B_in["w2"],
        "B_b2": _B_in["b2"],
    }

def reference(A_x, A_k_cache, A_v_cache, A_wq, A_wo, B_x, B_w1, B_b1, B_w2, B_b2):
    def _A_ref(x, k_cache, v_cache, wq, wo):
        B, Sq, D = x.shape
        H, Dh = 32, 128
        q = (lambda x, *d: x.permute(*d))((x @ wq).reshape(B, Sq, H, Dh), 0, 2, 1, 3)
        scores = torch.einsum("bhqd,bhkd->bhqk", q, k_cache) * (Dh ** -0.5)
        p = _softmax(scores, axis=-1)
        o = torch.einsum("bhqk,bhkd->bhqd", p, v_cache)
        return (lambda x, *d: x.permute(*d))(o, 0, 2, 1, 3).reshape(B, Sq, H * Dh) @ wo

    def _B_ref(x, w1, b1, w2, b2):
        B, S, D = x.shape
        h = _layernorm(x, axis=-1)
        u = torch.einsum("bsd,sf->bdf", h, w1) + b1
        u = _gelu(u)
        y = torch.einsum("bdf,fs->bds", u, w2) + b2
        return (lambda x, *d: x.permute(*d))(y, 0, 2, 1)

    x = A_x
    h = x + _A_ref(_layernorm(x, axis=-1), A_k_cache, A_v_cache, A_wq, A_wo)
    h2 = h + _B_ref(_layernorm(h, axis=-1), B_w1, B_b1, B_w2, B_b2)
    return h2
```

```asm
; @launch grid=(256,1,1) block=(512,1,1) lds=30208
.amdgcn_target "amdgcn-amd-amdhsa--gfx950"
.text
.globl sequential_preLN__mha_block_cached__mixer_token_mlp__decode_kernel
.p2align 8
.type sequential_preLN__mha_block_cached__mixer_token_mlp__decode_kernel,@function
sequential_preLN__mha_block_cached__mixer_token_mlp__decode_kernel:
s_cmp_ge_u32 s2, 256
s_cbranch_scc1 L_end
s_memrealtime s[62:63]
s_load_dwordx16 s[16:31], s[0:1], 0
s_load_dwordx8 s[32:39], s[0:1], 64
s_load_dwordx2 s[40:41], s[0:1], 96
v_lshrrev_b32 v58, 6, v0
v_and_b32 v1, 63, v0
v_readfirstlane_b32 s3, v58
s_and_b32 s5, s2, 31
s_lshr_b32 s6, s2, 7
s_bfe_u32 s7, s2, 0x20005
s_lshl_b32 s8, s5, 2
s_add_u32 s8, s8, s7
s_lshl_b32 s10, s6, 7
s_add_u32 s8, s8, s10
s_and_b32 s4, s3, 3
v_mov_b32 v57, 0
v_lshrrev_b32 v59, 4, v1
v_and_b32 v60, 15, v1
s_cmp_lg_u32 s3, 0
s_cbranch_scc1 L_notq
L_qwave:
s_lshr_b32 s10, s2, 5
s_mul_i32 s12, s10, 655360
v_lshlrev_b32 v2, 13, v59
v_lshl_add_u32 v2, v60, 4, v2
v_add_u32 v2, s12, v2
v_lshlrev_b32 v61, 2, v1
s_mul_i32 s11, s10, 160
v_lshlrev_b32 v62, 3, v60
v_lshl_add_u32 v62, v59, 1, v62
v_add_u32 v62, s11, v62
v_mov_b32 v16, 0
v_mov_b32 v17, 0
v_mov_b32 v18, 0
v_mov_b32 v19, 0
s_lshl_b32 s12, s5, 8
s_mov_b32 s9, 0
s_mov_b32 s54, 2560
s_mov_b32 s55, 0x20000
s_sub_u32 s46, 5242880, s12
s_mov_b32 s47, 0x20000
s_waitcnt lgkmcnt(0)
s_mov_b32 s52, s16
s_mov_b32 s53, s17
buffer_load_dword v80, v61, s[52:55], 0 offen offset:0
buffer_load_dword v81, v61, s[52:55], 0 offen offset:256
buffer_load_dword v82, v61, s[52:55], 0 offen offset:512
buffer_load_dword v83, v61, s[52:55], 0 offen offset:768
buffer_load_dword v84, v61, s[52:55], 0 offen offset:1024
buffer_load_dword v85, v61, s[52:55], 0 offen offset:1280
buffer_load_dword v86, v61, s[52:55], 0 offen offset:1536
buffer_load_dword v87, v61, s[52:55], 0 offen offset:1792
buffer_load_dword v88, v61, s[52:55], 0 offen offset:2048
buffer_load_dword v89, v61, s[52:55], 0 offen offset:2304
buffer_load_short_d16_hi v16, v62, s[52:55], 0 offen offset:0
buffer_load_short_d16_hi v17, v62, s[52:55], 0 offen offset:128
buffer_load_short_d16_hi v18, v62, s[52:55], 0 offen offset:1280
buffer_load_short_d16_hi v19, v62, s[52:55], 0 offen offset:1408
s_add_u32 s44, s22, s12
s_addc_u32 s45, s23, 0
buffer_load_dwordx4 v[96:99], v2, s[44:47], s9 offen nt
s_add_u32 s9, s9, 0x8000
buffer_load_dwordx4 v[100:103], v2, s[44:47], s9 offen nt
s_add_u32 s9, s9, 0x8000
buffer_load_dwordx4 v[104:107], v2, s[44:47], s9 offen nt
s_add_u32 s9, s9, 0x8000
buffer_load_dwordx4 v[108:111], v2, s[44:47], s9 offen nt
s_add_u32 s9, s9, 0x8000
buffer_load_dwordx4 v[112:115], v2, s[44:47], s9 offen nt
s_add_u32 s9, s9, 0x8000
buffer_load_dwordx4 v[116:119], v2, s[44:47], s9 offen nt
s_add_u32 s9, s9, 0x8000
buffer_load_dwordx4 v[120:123], v2, s[44:47], s9 offen nt
s_add_u32 s9, s9, 0x8000
buffer_load_dwordx4 v[124:127], v2, s[44:47], s9 offen nt
s_add_u32 s9, s9, 0x8000
buffer_load_dwordx4 v[128:131], v2, s[44:47], s9 offen nt
s_add_u32 s9, s9, 0x8000
buffer_load_dwordx4 v[132:135], v2, s[44:47], s9 offen nt
s_add_u32 s9, s9, 0x8000
buffer_load_dwordx4 v[136:139], v2, s[44:47], s9 offen nt
s_add_u32 s9, s9, 0x8000
buffer_load_dwordx4 v[140:143], v2, s[44:47], s9 offen nt
s_add_u32 s9, s9, 0x8000
buffer_load_dwordx4 v[144:147], v2, s[44:47], s9 offen nt
s_add_u32 s9, s9, 0x8000
buffer_load_dwordx4 v[148:151], v2, s[44:47], s9 offen nt
s_add_u32 s9, s9, 0x8000
buffer_load_dwordx4 v[152:155], v2, s[44:47], s9 offen nt
s_add_u32 s9, s9, 0x8000
buffer_load_dwordx4 v[156:159], v2, s[44:47], s9 offen nt
s_add_u32 s9, s9, 0x8000
buffer_load_dwordx4 v[160:163], v2, s[44:47], s9 offen nt
s_add_u32 s9, s9, 0x8000
buffer_load_dwordx4 v[164:167], v2, s[44:47], s9 offen nt
s_add_u32 s9, s9, 0x8000
buffer_load_dwordx4 v[168:171], v2, s[44:47], s9 offen nt
s_add_u32 s9, s9, 0x8000
buffer_load_dwordx4 v[172:175], v2, s[44:47], s9 offen nt
s_add_u32 s9, s9, 0x8000
s_barrier
s_load_dwordx2 s[92:93], s[40:41], 16384
s_load_dword s26, s[34:35], 0
s_mov_b32 s56, s40
s_mov_b32 s57, s41
s_mov_b32 s58, 2097152
s_mov_b32 s59, 0x20000
s_mov_b32 s52, s16
s_mov_b32 s53, s17
s_mov_b32 s54, 2560
s_mov_b32 s55, 0x20000
v_bfe_u32 v63, v1, 3, 1
v_mul_u32_u24 v63, 0x0202, v63
v_add_u32 v63, 0x0100, v63
v_or_b32 v64, 0x0c0c0000, v63
v_lshlrev_b32 v65, 16, v63
v_or_b32 v65, 0x0c0c, v65
v_and_b32 v63, 1, v1
v_cmp_eq_u32 vcc, 1, v63
v_bfe_u32 v66, v1, 1, 2
v_mov_b32 v67, 0x0c0c0c0c
v_cndmask_b32 v64, v64, v65, vcc
v_cmp_eq_u32 vcc, 0, v66
s_nop 1
v_cndmask_b32 v24, v67, v64, vcc
v_cmp_eq_u32 vcc, 1, v66
s_nop 1
v_cndmask_b32 v25, v67, v64, vcc
v_cmp_eq_u32 vcc, 2, v66
s_nop 1
v_cndmask_b32 v26, v67, v64, vcc
v_cmp_eq_u32 vcc, 3, v66
s_nop 1
v_cndmask_b32 v27, v67, v64, vcc
v_lshlrev_b32 v32, 4, v1
s_waitcnt vmcnt(20)
v_lshlrev_b32 v36, 16, v80
v_and_b32 v37, 0xffff0000, v80
v_lshlrev_b32 v38, 16, v81
v_and_b32 v39, 0xffff0000, v81
v_lshlrev_b32 v40, 16, v82
v_and_b32 v41, 0xffff0000, v82
v_lshlrev_b32 v42, 16, v83
v_and_b32 v43, 0xffff0000, v83
v_lshlrev_b32 v44, 16, v84
v_and_b32 v45, 0xffff0000, v84
v_lshlrev_b32 v46, 16, v85
v_and_b32 v47, 0xffff0000, v85
v_lshlrev_b32 v48, 16, v86
v_and_b32 v49, 0xffff0000, v86
v_lshlrev_b32 v50, 16, v87
v_and_b32 v51, 0xffff0000, v87
v_lshlrev_b32 v52, 16, v88
v_and_b32 v53, 0xffff0000, v88
v_lshlrev_b32 v54, 16, v89
v_and_b32 v55, 0xffff0000, v89
v_readfirstlane_b32 s42, v36
v_readfirstlane_b32 s43, v46
s_nop 1
v_subrev_f32 v62, s42, v36
v_mov_b32 v70, v62
v_mul_f32 v71, v62, v62
v_subrev_f32 v66, s43, v46
v_mov_b32 v72, v66
v_mul_f32 v73, v66, v66
v_subrev_f32 v63, s42, v37
v_add_f32 v70, v70, v63
v_fmac_f32 v71, v63, v63
v_subrev_f32 v67, s43, v47
v_add_f32 v72, v72, v67
v_fmac_f32 v73, v67, v67
v_subrev_f32 v64, s42, v38
v_add_f32 v70, v70, v64
v_fmac_f32 v71, v64, v64
v_subrev_f32 v68, s43, v48
v_add_f32 v72, v72, v68
v_fmac_f32 v73, v68, v68
v_subrev_f32 v65, s42, v39
v_add_f32 v70, v70, v65
v_fmac_f32 v71, v65, v65
v_subrev_f32 v69, s43, v49
v_add_f32 v72, v72, v69
v_fmac_f32 v73, v69, v69
v_subrev_f32 v62, s42, v40
v_add_f32 v70, v70, v62
v_fmac_f32 v71, v62, v62
v_subrev_f32 v66, s43, v50
v_add_f32 v72, v72, v66
v_fmac_f32 v73, v66, v66
v_subrev_f32 v63, s42, v41
v_add_f32 v70, v70, v63
v_fmac_f32 v71, v63, v63
v_subrev_f32 v67, s43, v51
v_add_f32 v72, v72, v67
v_fmac_f32 v73, v67, v67
v_subrev_f32 v64, s42, v42
v_add_f32 v70, v70, v64
v_fmac_f32 v71, v64, v64
v_subrev_f32 v68, s43, v52
v_add_f32 v72, v72, v68
v_fmac_f32 v73, v68, v68
v_subrev_f32 v65, s42, v43
v_add_f32 v70, v70, v65
v_fmac_f32 v71, v65, v65
v_subrev_f32 v69, s43, v53
v_add_f32 v72, v72, v69
v_fmac_f32 v73, v69, v69
v_subrev_f32 v62, s42, v44
v_add_f32 v70, v70, v62
v_fmac_f32 v71, v62, v62
v_subrev_f32 v66, s43, v54
v_add_f32 v72, v72, v66
v_fmac_f32 v73, v66, v66
v_subrev_f32 v63, s42, v45
v_add_f32 v70, v70, v63
v_fmac_f32 v71, v63, v63
v_subrev_f32 v67, s43, v55
v_add_f32 v72, v72, v67
v_fmac_f32 v73, v67, v67
s_nop 1
v_add_f32_dpp v70, v70, v70 quad_perm:[1,0,3,2] row_mask:0xf bank_mask:0xf
v_add_f32_dpp v71, v71, v71 quad_perm:[1,0,3,2] row_mask:0xf bank_mask:0xf
v_add_f32_dpp v72, v72, v72 quad_perm:[1,0,3,2] row_mask:0xf bank_mask:0xf
v_add_f32_dpp v73, v73, v73 quad_perm:[1,0,3,2] row_mask:0xf bank_mask:0xf
v_add_f32_dpp v70, v70, v70 quad_perm:[2,3,0,1] row_mask:0xf bank_mask:0xf
v_add_f32_dpp v71, v71, v71 quad_perm:[2,3,0,1] row_mask:0xf bank_mask:0xf
v_add_f32_dpp v72, v72, v72 quad_perm:[2,3,0,1] row_mask:0xf bank_mask:0xf
v_add_f32_dpp v73, v73, v73 quad_perm:[2,3,0,1] row_mask:0xf bank_mask:0xf
v_add_f32_dpp v70, v70, v70 row_half_mirror row_mask:0xf bank_mask:0xf
v_add_f32_dpp v71, v71, v71 row_half_mirror row_mask:0xf bank_mask:0xf
v_add_f32_dpp v72, v72, v72 row_half_mirror row_mask:0xf bank_mask:0xf
v_add_f32_dpp v73, v73, v73 row_half_mirror row_mask:0xf bank_mask:0xf
v_add_f32_dpp v70, v70, v70 row_mirror row_mask:0xf bank_mask:0xf
v_add_f32_dpp v71, v71, v71 row_mirror row_mask:0xf bank_mask:0xf
v_add_f32_dpp v72, v72, v72 row_mirror row_mask:0xf bank_mask:0xf
v_add_f32_dpp v73, v73, v73 row_mirror row_mask:0xf bank_mask:0xf
v_add_f32_dpp v70, v70, v70 row_bcast:15 row_mask:0xa bank_mask:0xf
v_add_f32_dpp v71, v71, v71 row_bcast:15 row_mask:0xa bank_mask:0xf
v_add_f32_dpp v72, v72, v72 row_bcast:15 row_mask:0xa bank_mask:0xf
v_add_f32_dpp v73, v73, v73 row_bcast:15 row_mask:0xa bank_mask:0xf
v_add_f32_dpp v70, v70, v70 row_bcast:31 row_mask:0xc bank_mask:0xf
v_add_f32_dpp v71, v71, v71 row_bcast:31 row_mask:0xc bank_mask:0xf
v_add_f32_dpp v72, v72, v72 row_bcast:31 row_mask:0xc bank_mask:0xf
v_add_f32_dpp v73, v73, v73 row_bcast:31 row_mask:0xc bank_mask:0xf
s_nop 0
v_readlane_b32 s10, v70, 63
v_readlane_b32 s11, v71, 63
v_readlane_b32 s12, v72, 63
v_readlane_b32 s13, v73, 63
v_mov_b32 v62, 0x3acccccd
s_nop 0
v_mul_f32 v70, s10, v62
v_mul_f32 v72, s12, v62
v_mul_f32 v71, s11, v62
v_mul_f32 v73, s13, v62
v_fma_f32 v71, -v70, v70, v71
v_fma_f32 v73, -v72, v72, v73
v_add_f32 v70, s42, v70
v_add_f32 v72, s43, v72
v_max_f32 v71, 0, v71
v_max_f32 v73, 0, v73
v_cvt_pk_bf16_f32 v74, 0, v70
v_cvt_pk_bf16_f32 v76, 0, v72
v_cvt_pk_bf16_f32 v71, 0, v71
v_cvt_pk_bf16_f32 v73, 0, v73
v_add_f32 v71, 0x3727c5ac, v71
v_add_f32 v73, 0x3727c5ac, v73
v_cvt_pk_bf16_f32 v71, 0, v71
v_cvt_pk_bf16_f32 v73, 0, v73
v_sqrt_f32 v71, v71
v_sqrt_f32 v73, v73
s_nop 0
v_cvt_pk_bf16_f32 v71, 0, v71
v_cvt_pk_bf16_f32 v73, 0, v73
v_rcp_f32 v75, v71
v_rcp_f32 v77, v73
s_nop 0
v_sub_f32 v16, v16, v74
v_sub_f32 v17, v17, v74
v_sub_f32 v18, v18, v76
v_sub_f32 v19, v19, v76
v_cvt_pk_bf16_f32 v16, 0, v16
v_cvt_pk_bf16_f32 v17, 0, v17
v_cvt_pk_bf16_f32 v18, 0, v18
v_cvt_pk_bf16_f32 v19, 0, v19
v_mul_f32 v16, v16, v75
v_mul_f32 v17, v17, v75
v_mul_f32 v18, v18, v77
v_mul_f32 v19, v19, v77
v_cvt_pk_bf16_f32 v20, v16, v18
v_cvt_pk_bf16_f32 v21, v17, v19
s_waitcnt lgkmcnt(0)
s_add_u32 s92, s92, 1
s_add_u32 s93, s93, 1
v_mov_b32_dpp v58, v20 row_newbcast:0 row_mask:0xf bank_mask:0xf
v_perm_b32 v8, v58, v58, v24
v_perm_b32 v9, v58, v58, v25
v_perm_b32 v10, v58, v58, v26
v_perm_b32 v11, v58, v58, v27
v_mov_b32 v37, s92
v_mov_b32 v39, s93
v_mov_b32 v41, s92
v_mov_b32 v43, s93
s_waitcnt vmcnt(19)
s_nop 0
v_mfma_f32_16x16x32_bf16 v[28:31], v[8:11], v[96:99], 0
v_mov_b32_dpp v59, v20 row_newbcast:1 row_mask:0xf bank_mask:0xf
v_perm_b32 v12, v59, v59, v24
v_perm_b32 v13, v59, v59, v25
v_perm_b32 v14, v59, v59, v26
v_perm_b32 v15, v59, v59, v27
s_waitcnt vmcnt(18)
s_nop 0
v_mfma_f32_16x16x32_bf16 v[28:31], v[12:15], v[100:103], v[28:31]
v_mov_b32_dpp v58, v20 row_newbcast:2 row_mask:0xf bank_mask:0xf
v_perm_b32 v8, v58, v58, v24
v_perm_b32 v9, v58, v58, v25
v_perm_b32 v10, v58, v58, v26
v_perm_b32 v11, v58, v58, v27
s_waitcnt vmcnt(17)
s_nop 0
v_mfma_f32_16x16x32_bf16 v[28:31], v[8:11], v[104:107], v[28:31]
v_mov_b32_dpp v59, v20 row_newbcast:3 row_mask:0xf bank_mask:0xf
v_perm_b32 v12, v59, v59, v24
v_perm_b32 v13, v59, v59, v25
v_perm_b32 v14, v59, v59, v26
v_perm_b32 v15, v59, v59, v27
s_waitcnt vmcnt(16)
s_nop 0
v_mfma_f32_16x16x32_bf16 v[28:31], v[12:15], v[108:111], v[28:31]
v_mov_b32_dpp v58, v20 row_newbcast:4 row_mask:0xf bank_mask:0xf
v_perm_b32 v8, v58, v58, v24
v_perm_b32 v9, v58, v58, v25
v_perm_b32 v10, v58, v58, v26
v_perm_b32 v11, v58, v58, v27
s_waitcnt vmcnt(15)
s_nop 0
v_mfma_f32_16x16x32_bf16 v[28:31], v[8:11], v[112:115], v[28:31]
v_mov_b32_dpp v59, v20 row_newbcast:5 row_mask:0xf bank_mask:0xf
v_perm_b32 v12, v59, v59, v24
v_perm_b32 v13, v59, v59, v25
v_perm_b32 v14, v59, v59, v26
v_perm_b32 v15, v59, v59, v27
s_waitcnt vmcnt(14)
s_nop 0
v_mfma_f32_16x16x32_bf16 v[28:31], v[12:15], v[116:119], v[28:31]
v_mov_b32_dpp v58, v20 row_newbcast:6 row_mask:0xf bank_mask:0xf
v_perm_b32 v8, v58, v58, v24
v_perm_b32 v9, v58, v58, v25
v_perm_b32 v10, v58, v58, v26
v_perm_b32 v11, v58, v58, v27
s_waitcnt vmcnt(13)
s_nop 0
v_mfma_f32_16x16x32_bf16 v[28:31], v[8:11], v[120:123], v[28:31]
v_mov_b32_dpp v59, v20 row_newbcast:7 row_mask:0xf bank_mask:0xf
v_perm_b32 v12, v59, v59, v24
v_perm_b32 v13, v59, v59, v25
v_perm_b32 v14, v59, v59, v26
v_perm_b32 v15, v59, v59, v27
s_waitcnt vmcnt(12)
s_nop 0
v_mfma_f32_16x16x32_bf16 v[28:31], v[12:15], v[124:127], v[28:31]
v_mov_b32_dpp v58, v20 row_newbcast:8 row_mask:0xf bank_mask:0xf
v_perm_b32 v8, v58, v58, v24
v_perm_b32 v9, v58, v58, v25
v_perm_b32 v10, v58, v58, v26
v_perm_b32 v11, v58, v58, v27
s_waitcnt vmcnt(11)
s_nop 0
v_mfma_f32_16x16x32_bf16 v[28:31], v[8:11], v[128:131], v[28:31]
v_mov_b32_dpp v59, v20 row_newbcast:9 row_mask:0xf bank_mask:0xf
v_perm_b32 v12, v59, v59, v24
v_perm_b32 v13, v59, v59, v25
v_perm_b32 v14, v59, v59, v26
v_perm_b32 v15, v59, v59, v27
s_waitcnt vmcnt(10)
s_nop 0
v_mfma_f32_16x16x32_bf16 v[28:31], v[12:15], v[132:135], v[28:31]
v_mov_b32_dpp v58, v20 row_newbcast:10 row_mask:0xf bank_mask:0xf
v_perm_b32 v8, v58, v58, v24
v_perm_b32 v9, v58, v58, v25
v_perm_b32 v10, v58, v58, v26
v_perm_b32 v11, v58, v58, v27
s_waitcnt vmcnt(9)
s_nop 0
v_mfma_f32_16x16x32_bf16 v[28:31], v[8:11], v[136:139], v[28:31]
v_mov_b32_dpp v59, v20 row_newbcast:11 row_mask:0xf bank_mask:0xf
v_perm_b32 v12, v59, v59, v24
v_perm_b32 v13, v59, v59, v25
v_perm_b32 v14, v59, v59, v26
v_perm_b32 v15, v59, v59, v27
s_waitcnt vmcnt(8)
s_nop 0
v_mfma_f32_16x16x32_bf16 v[28:31], v[12:15], v[140:143], v[28:31]
v_mov_b32_dpp v58, v20 row_newbcast:12 row_mask:0xf bank_mask:0xf
v_perm_b32 v8, v58, v58, v24
v_perm_b32 v9, v58, v58, v25
v_perm_b32 v10, v58, v58, v26
v_perm_b32 v11, v58, v58, v27
s_waitcnt vmcnt(7)
s_nop 0
v_mfma_f32_16x16x32_bf16 v[28:31], v[8:11], v[144:147], v[28:31]
v_mov_b32_dpp v59, v20 row_newbcast:13 row_mask:0xf bank_mask:0xf
v_perm_b32 v12, v59, v59, v24
v_perm_b32 v13, v59, v59, v25
v_perm_b32 v14, v59, v59, v26
v_perm_b32 v15, v59, v59, v27
s_waitcnt vmcnt(6)
s_nop 0
v_mfma_f32_16x16x32_bf16 v[28:31], v[12:15], v[148:151], v[28:31]
v_mov_b32_dpp v58, v20 row_newbcast:14 row_mask:0xf bank_mask:0xf
v_perm_b32 v8, v58, v58, v24
v_perm_b32 v9, v58, v58, v25
v_perm_b32 v10, v58, v58, v26
v_perm_b32 v11, v58, v58, v27
s_waitcnt vmcnt(5)
s_nop 0
v_mfma_f32_16x16x32_bf16 v[28:31], v[8:11], v[152:155], v[28:31]
v_mov_b32_dpp v59, v20 row_newbcast:15 row_mask:0xf bank_mask:0xf
v_perm_b32 v12, v59, v59, v24
v_perm_b32 v13, v59, v59, v25
v_perm_b32 v14, v59, v59, v26
v_perm_b32 v15, v59, v59, v27
s_waitcnt vmcnt(4)
s_nop 0
v_mfma_f32_16x16x32_bf16 v[28:31], v[12:15], v[156:159], v[28:31]
v_mov_b32_dpp v58, v21 row_newbcast:0 row_mask:0xf bank_mask:0xf
v_perm_b32 v8, v58, v58, v24
v_perm_b32 v9, v58, v58, v25
v_perm_b32 v10, v58, v58, v26
v_perm_b32 v11, v58, v58, v27
s_waitcnt vmcnt(3)
s_nop 0
v_mfma_f32_16x16x32_bf16 v[28:31], v[8:11], v[160:163], v[28:31]
v_mov_b32_dpp v59, v21 row_newbcast:1 row_mask:0xf bank_mask:0xf
v_perm_b32 v12, v59, v59, v24
v_perm_b32 v13, v59, v59, v25
v_perm_b32 v14, v59, v59, v26
v_perm_b32 v15, v59, v59, v27
s_waitcnt vmcnt(2)
s_nop 0
v_mfma_f32_16x16x32_bf16 v[28:31], v[12:15], v[164:167], v[28:31]
v_mov_b32_dpp v58, v21 row_newbcast:2 row_mask:0xf bank_mask:0xf
v_perm_b32 v8, v58, v58, v24
v_perm_b32 v9, v58, v58, v25
v_perm_b32 v10, v58, v58, v26
v_perm_b32 v11, v58, v58, v27
s_waitcnt vmcnt(1)
s_nop 0
v_mfma_f32_16x16x32_bf16 v[28:31], v[8:11], v[168:171], v[28:31]
v_mov_b32_dpp v59, v21 row_newbcast:3 row_mask:0xf bank_mask:0xf
v_perm_b32 v12, v59, v59, v24
v_perm_b32 v13, v59, v59, v25
v_perm_b32 v14, v59, v59, v26
v_perm_b32 v15, v59, v59, v27
s_waitcnt vmcnt(0)
s_nop 0
v_mfma_f32_16x16x32_bf16 v[28:31], v[12:15], v[172:175], v[28:31]
s_lshr_b32 s10, s2, 5
s_lshl_b32 s10, s10, 11
s_lshl_b32 s11, s5, 14
s_add_u32 s11, s11, 1572864
s_add_u32 s10, s10, s11
v_and_b32 v58, 31, v1
v_lshrrev_b32 v59, 5, v1
v_lshlrev_b32 v58, 4, v58
v_mov_b32 v36, v28
v_mov_b32 v38, v29
v_mov_b32 v40, v30
v_mov_b32 v42, v31
buffer_store_dwordx4 v[36:39], v32, s[56:59], s10 offen sc1
buffer_store_dwordx4 v[40:43], v32, s[56:59], s10 offen offset:1024 sc1
L_qgather:
v_lshl_add_u32 v58, v59, 10, v58
v_add_u32 v59, 0x1000, v58
v_add_u32 v60, 0x2000, v58
s_lshl_b32 s10, s6, 9
s_add_u32 s11, s11, s10
v_add_u32 v62, 0x3000, v58
s_mov_b32 s15, 200000
s_sleep 40
L_qpf_276:
buffer_load_dwordx4 v[176:179], v58, s[56:59], s11 offen offset:0 sc1
buffer_load_dwordx4 v[180:183], v58, s[56:59], s11 offen offset:2048 sc1
buffer_load_dwordx4 v[184:187], v59, s[56:59], s11 offen offset:0 sc1
buffer_load_dwordx4 v[188:191], v59, s[56:59], s11 offen offset:2048 sc1
buffer_load_dwordx4 v[192:195], v60, s[56:59], s11 offen offset:0 sc1
buffer_load_dwordx4 v[196:199], v60, s[56:59], s11 offen offset:2048 sc1
buffer_load_dwordx4 v[200:203], v62, s[56:59], s11 offen offset:0 sc1
buffer_load_dwordx4 v[204:207], v62, s[56:59], s11 offen offset:2048 sc1
L_qchk:
v_and_b32 v63, 1, v1
v_mov_b32 v64, 0xffff
v_cmp_eq_u32 vcc, 1, v63
v_mov_b32 v65, 0xffff0000
v_bfe_u32 v66, v1, 1, 3
v_cndmask_b32 v64, v64, v65, vcc
v_cmp_eq_u32 vcc, 0, v66
s_nop 1
v_cndmask_b32 v4, 0, v64, vcc
v_cmp_eq_u32 vcc, 1, v66
s_nop 1
v_cndmask_b32 v5, 0, v64, vcc
v_cmp_eq_u32 vcc, 2, v66
s_nop 1
v_cndmask_b32 v6, 0, v64, vcc
v_cmp_eq_u32 vcc, 3, v66
s_nop 1
v_cndmask_b32 v7, 0, v64, vcc
s_waitcnt vmcnt(0)
v_xor_b32 v177, s92, v177
v_xor_b32 v179, s93, v179
v_or_b32 v63, v177, v179
v_xor_b32 v181, s92, v181
v_xor_b32 v183, s93, v183
v_or3_b32 v63, v63, v181, v183
v_xor_b32 v185, s92, v185
v_xor_b32 v187, s93, v187
v_or3_b32 v63, v63, v185, v187
v_xor_b32 v189, s92, v189
v_xor_b32 v191, s93, v191
v_or3_b32 v63, v63, v189, v191
v_xor_b32 v193, s92, v193
v_xor_b32 v195, s93, v195
v_or3_b32 v63, v63, v193, v195
v_xor_b32 v197, s92, v197
v_xor_b32 v199, s93, v199
v_or3_b32 v63, v63, v197, v199
v_xor_b32 v201, s92, v201
v_xor_b32 v203, s93, v203
v_or3_b32 v63, v63, v201, v203
v_xor_b32 v205, s92, v205
v_xor_b32 v207, s93, v207
v_or3_b32 v63, v63, v205, v207
v_cmp_ne_u32 vcc, 0, v63
s_sub_u32 s15, s15, 1
s_cbranch_scc1 L_qpd_275
s_cbranch_vccz L_qpd_275
s_sleep 8
s_branch L_qpf_276
L_qpd_275:
v_add_f32 v176, v176, v192
v_add_f32 v178, v178, v194
v_add_f32 v180, v180, v196
v_add_f32 v182, v182, v198
v_add_f32 v184, v184, v200
v_add_f32 v186, v186, v202
v_add_f32 v188, v188, v204
v_add_f32 v190, v190, v206
v_add_f32 v176, v176, v184
v_add_f32 v178, v178, v186
v_add_f32 v180, v180, v188
v_add_f32 v182, v182, v190
v_add_f32 v176, v176, v180
v_add_f32 v178, v178, v182
v_cvt_pk_bf16_f32 v59, v176, v178
v_and_b32 v58, 15, v1
v_bfe_u32 v60, v1, 4, 1
v_lshrrev_b32 v61, 5, v1
v_lshlrev_b32 v58, 4, v58
v_lshl_add_u32 v58, v60, 3, v58
v_lshl_add_u32 v58, v61, 2, v58
ds_write_b32 v58, v59 offset:0
v_mov_b32 v62, s92
v_mov_b32 v63, s93
ds_write_b64 v57, v[62:63] offset:320
s_mul_i32 s12, s4, 40960
v_lshrrev_b32 v59, 4, v1
v_and_b32 v60, 15, v1
v_mul_u32_u24 v3, 1280, v59
v_lshl_add_u32 v3, v60, 4, v3
v_add_u32 v3, s12, v3
s_mul_i32 s13, s5, 163840
s_add_u32 s48, s24, s13
s_addc_u32 s49, s25, 0
s_mov_b32 s50, 163840
s_mov_b32 s51, 0x20000
s_waitcnt lgkmcnt(0)
s_barrier
s_branch L_hjoin
L_notq:
s_cmp_ge_u32 s3, 4
s_cbranch_scc1 L_swave
s_barrier
s_branch L_h123
L_swave:
v_bfe_u32 v61, v1, 2, 2
v_and_b32 v62, 3, v1
s_lshl_b32 s10, s4, 10
v_lshlrev_b32 v2, 8, v61
v_lshl_add_u32 v2, v59, 6, v2
v_lshl_add_u32 v2, v62, 4, v2
v_add_u32 v2, s10, v2
v_lshl_add_u32 v3, v1, 4, s10
s_lshl_b32 s11, s8, 19
s_mov_b32 s9, 0
v_and_b32 v63, 1, v1
v_mov_b32 v64, 0xffff
v_cmp_eq_u32 vcc, 1, v63
v_mov_b32 v65, 0xffff0000
v_bfe_u32 v66, v1, 1, 3
v_cndmask_b32 v64, v64, v65, vcc
v_cmp_eq_u32 vcc, 0, v66
s_nop 1
v_cndmask_b32 v4, 0, v64, vcc
v_cmp_eq_u32 vcc, 1, v66
s_nop 1
v_cndmask_b32 v5, 0, v64, vcc
v_cmp_eq_u32 vcc, 2, v66
s_nop 1
v_cndmask_b32 v6, 0, v64, vcc
v_cmp_eq_u32 vcc, 3, v66
s_nop 1
v_cndmask_b32 v7, 0, v64, vcc
s_mov_b32 s96, 0x22222222
s_mov_b32 s97, 0x22222222
s_mov_b32 s98, 0x44444444
s_mov_b32 s99, 0x44444444
s_mov_b32 s100, 0x88888888
s_mov_b32 s101, 0x88888888
v_lshlrev_b32 v56, 6, v59
v_lshl_add_u32 v56, v62, 4, v56
s_mov_b32 s42, 0x3db504f3
s_waitcnt lgkmcnt(0)
s_add_u32 s44, s18, s11
s_addc_u32 s45, s19, 0
s_mov_b32 s46, 0x80000
s_mov_b32 s47, 0x20000
s_add_u32 s48, s20, s11
s_addc_u32 s49, s21, 0
s_mov_b32 s50, 0x80000
s_mov_b32 s51, 0x20000
s_load_dword s26, s[34:35], 0
s_mov_b32 s56, s40
s_mov_b32 s57, s41
s_mov_b32 s58, 2097152
s_mov_b32 s59, 0x20000
s_mov_b32 s52, s16
s_mov_b32 s53, s17
s_mov_b32 s54, 2560
s_mov_b32 s55, 0x20000
s_barrier
buffer_load_dwordx4 v[80:83], v2, s[44:47], s9 offen nt
s_addk_i32 s9, 0x1000
buffer_load_dwordx4 v[84:87], v2, s[44:47], s9 offen nt
s_addk_i32 s9, 0x1000
buffer_load_dwordx4 v[88:91], v2, s[44:47], s9 offen nt
s_addk_i32 s9, 0x1000
buffer_load_dwordx4 v[92:95], v2, s[44:47], s9 offen nt
s_addk_i32 s9, 0x1000
buffer_load_dwordx4 v[96:99], v2, s[44:47], s9 offen nt
s_addk_i32 s9, 0x1000
s_waitcnt vmcnt(4)
buffer_load_dwordx4 v[100:103], v2, s[44:47], s9 offen nt
s_addk_i32 s9, 0x1000
s_waitcnt vmcnt(4)
buffer_load_dwordx4 v[104:107], v2, s[44:47], s9 offen nt
s_addk_i32 s9, 0x1000
s_waitcnt vmcnt(4)
buffer_load_dwordx4 v[108:111], v2, s[44:47], s9 offen nt
s_addk_i32 s9, 0x1000
s_memrealtime s[60:61]
s_waitcnt vmcnt(4)
buffer_load_dwordx4 v[112:115], v2, s[44:47], s9 offen nt
s_addk_i32 s9, 0x1000
s_waitcnt vmcnt(4)
buffer_load_dwordx4 v[116:119], v2, s[44:47], s9 offen nt
s_addk_i32 s9, 0x1000
s_waitcnt vmcnt(4)
buffer_load_dwordx4 v[120:123], v2, s[44:47], s9 offen nt
s_addk_i32 s9, 0x1000
s_waitcnt vmcnt(4)
buffer_load_dwordx4 v[124:127], v2, s[44:47], s9 offen nt
s_addk_i32 s9, 0x1000
s_waitcnt lgkmcnt(0)
s_sub_u32 s60, s60, s62
s_cmp_gt_u32 s60, 260
s_cselect_b64 vcc, -1, 0
s_waitcnt vmcnt(4)
buffer_load_dwordx4 v[128:131], v2, s[44:47], s9 offen nt
s_addk_i32 s9, 0x1000
s_cbranch_vccnz L_fb_1
s_waitcnt vmcnt(4)
L_fb_1:
buffer_load_dwordx4 v[132:135], v2, s[44:47], s9 offen nt
s_addk_i32 s9, 0x1000
s_cbranch_vccnz L_fb_2
s_waitcnt vmcnt(4)
L_fb_2:
buffer_load_dwordx4 v[136:139], v2, s[44:47], s9 offen nt
s_addk_i32 s9, 0x1000
s_cbranch_vccnz L_fb_3
s_waitcnt vmcnt(4)
L_fb_3:
s_waitcnt vmcnt(6)
buffer_load_dwordx4 v[140:143], v2, s[44:47], s9 offen nt
s_addk_i32 s9, 0x1000
s_cbranch_vccnz L_fb_4
s_waitcnt vmcnt(4)
L_fb_4:
s_waitcnt vmcnt(6)
buffer_load_dwordx4 v[144:147], v2, s[44:47], s9 offen nt
s_addk_i32 s9, 0x1000
s_cbranch_vccnz L_fb_5
s_waitcnt vmcnt(4)
L_fb_5:
s_waitcnt vmcnt(6)
buffer_load_dwordx4 v[148:151], v2, s[44:47], s9 offen nt
s_addk_i32 s9, 0x1000
s_cbranch_vccnz L_fb_6
s_waitcnt vmcnt(4)
L_fb_6:
s_waitcnt vmcnt(6)
buffer_load_dwordx4 v[152:155], v2, s[44:47], s9 offen nt
s_addk_i32 s9, 0x1000
s_cbranch_vccnz L_fb_7
s_waitcnt vmcnt(4)
L_fb_7:
s_waitcnt vmcnt(6)
buffer_load_dwordx4 v[156:159], v2, s[44:47], s9 offen nt
s_addk_i32 s9, 0x1000
s_cbranch_vccnz L_fb_8
s_waitcnt vmcnt(4)
L_fb_8:
s_waitcnt vmcnt(6)
buffer_load_dwordx4 v[160:163], v2, s[44:47], s9 offen nt
s_addk_i32 s9, 0x1000
s_cbranch_vccnz L_fb_9
s_waitcnt vmcnt(4)
L_fb_9:
s_waitcnt vmcnt(6)
buffer_load_dwordx4 v[164:167], v2, s[44:47], s9 offen nt
s_addk_i32 s9, 0x1000
s_cbranch_vccnz L_fb_10
s_waitcnt vmcnt(4)
L_fb_10:
s_waitcnt vmcnt(6)
buffer_load_dwordx4 v[168:171], v2, s[44:47], s9 offen nt
s_addk_i32 s9, 0x1000
s_cbranch_vccnz L_fb_11
s_waitcnt vmcnt(4)
L_fb_11:
s_waitcnt vmcnt(6)
buffer_load_dwordx4 v[172:175], v2, s[44:47], s9 offen nt
s_addk_i32 s9, 0x1000
s_memrealtime s[60:61]
s_cbranch_vccnz L_fb_12
s_waitcnt vmcnt(4)
L_fb_12:
s_waitcnt vmcnt(6)
buffer_load_dwordx4 v[176:179], v2, s[44:47], s9 offen nt
s_addk_i32 s9, 0x1000
s_cbranch_vccnz L_fb_13
s_waitcnt vmcnt(4)
L_fb_13:
s_waitcnt vmcnt(6)
buffer_load_dwordx4 v[180:183], v2, s[44:47], s9 offen nt
s_addk_i32 s9, 0x1000
s_cbranch_vccnz L_fb_14
s_waitcnt vmcnt(4)
L_fb_14:
s_waitcnt vmcnt(6)
buffer_load_dwordx4 v[184:187], v2, s[44:47], s9 offen nt
s_addk_i32 s9, 0x1000
s_cbranch_vccnz L_fb_15
s_waitcnt vmcnt(4)
L_fb_15:
s_waitcnt vmcnt(6)
buffer_load_dwordx4 v[188:191], v2, s[44:47], s9 offen nt
s_addk_i32 s9, 0x1000
s_waitcnt lgkmcnt(0)
s_sub_u32 s60, s60, s62
s_cmp_gt_u32 s60, 505
s_cselect_b64 vcc, -1, 0
s_cbranch_vccnz L_fb_16
s_waitcnt vmcnt(4)
L_fb_16:
s_waitcnt vmcnt(6)
buffer_load_dwordx4 v[192:195], v2, s[44:47], s9 offen nt
s_addk_i32 s9, 0x1000
s_cbranch_vccnz L_fb_17
s_waitcnt vmcnt(4)
L_fb_17:
s_waitcnt vmcnt(6)
buffer_load_dwordx4 v[196:199], v2, s[44:47], s9 offen nt
s_addk_i32 s9, 0x1000
s_cbranch_vccnz L_fb_18
s_waitcnt vmcnt(4)
L_fb_18:
s_waitcnt vmcnt(6)
buffer_load_dwordx4 v[200:203], v2, s[44:47], s9 offen nt
s_addk_i32 s9, 0x1000
s_cbranch_vccnz L_fb_19
s_waitcnt vmcnt(4)
L_fb_19:
s_waitcnt vmcnt(6)
buffer_load_dwordx4 v[204:207], v2, s[44:47], s9 offen nt
s_addk_i32 s9, 0x1000
s_cbranch_vccnz L_fb_20
s_waitcnt vmcnt(4)
L_fb_20:
s_waitcnt vmcnt(6)
buffer_load_dwordx4 v[208:211], v2, s[44:47], s9 offen nt
s_addk_i32 s9, 0x1000
s_cbranch_vccnz L_fb_21
s_waitcnt vmcnt(4)
L_fb_21:
s_waitcnt vmcnt(6)
buffer_load_dwordx4 v[212:215], v2, s[44:47], s9 offen nt
s_addk_i32 s9, 0x1000
s_cbranch_vccnz L_fb_22
s_waitcnt vmcnt(4)
L_fb_22:
s_waitcnt vmcnt(6)
buffer_load_dwordx4 v[216:219], v2, s[44:47], s9 offen nt
s_addk_i32 s9, 0x1000
s_cbranch_vccnz L_fb_23
s_waitcnt vmcnt(4)
L_fb_23:
s_waitcnt vmcnt(6)
buffer_load_dwordx4 v[220:223], v2, s[44:47], s9 offen nt
s_addk_i32 s9, 0x1000
s_cbranch_vccnz L_fb_24
s_waitcnt vmcnt(4)
L_fb_24:
s_waitcnt vmcnt(6)
buffer_load_dwordx4 v[224:227], v2, s[44:47], s9 offen nt
s_addk_i32 s9, 0x1000
s_cbranch_vccnz L_fb_25
s_waitcnt vmcnt(4)
L_fb_25:
s_waitcnt vmcnt(6)
buffer_load_dwordx4 v[228:231], v2, s[44:47], s9 offen nt
s_addk_i32 s9, 0x1000
s_cbranch_vccnz L_fb_26
s_waitcnt vmcnt(4)
L_fb_26:
s_waitcnt vmcnt(6)
buffer_load_dwordx4 v[232:235], v2, s[44:47], s9 offen nt
s_addk_i32 s9, 0x1000
s_cbranch_vccnz L_fb_27
s_waitcnt vmcnt(4)
L_fb_27:
s_waitcnt vmcnt(6)
buffer_load_dwordx4 v[236:239], v2, s[44:47], s9 offen nt
s_addk_i32 s9, 0x1000
s_memrealtime s[60:61]
s_cbranch_vccnz L_fb_28
s_waitcnt vmcnt(4)
L_fb_28:
s_waitcnt vmcnt(6)
buffer_load_dwordx4 v[240:243], v2, s[44:47], s9 offen nt
s_addk_i32 s9, 0x1000
s_cbranch_vccnz L_fb_29
s_waitcnt vmcnt(4)
L_fb_29:
s_waitcnt vmcnt(6)
buffer_load_dwordx4 v[244:247], v2, s[44:47], s9 offen nt
s_addk_i32 s9, 0x1000
s_cbranch_vccnz L_fb_30
s_waitcnt vmcnt(4)
L_fb_30:
s_waitcnt vmcnt(6)
buffer_load_dwordx4 v[248:251], v2, s[44:47], s9 offen nt
s_addk_i32 s9, 0x1000
s_cbranch_vccnz L_fb_31
s_waitcnt vmcnt(4)
L_fb_31:
s_waitcnt vmcnt(6)
buffer_load_dwordx4 v[252:255], v2, s[44:47], s9 offen nt
s_addk_i32 s9, 0x1000
s_barrier
ds_read_b128 v[64:67], v56 offset:0
v_mov_b32 v68, 0
ds_read_b64 v[68:69], v68 offset:320
s_waitcnt lgkmcnt(0)
v_readfirstlane_b32 s92, v68
v_readfirstlane_b32 s93, v69
v_cmp_eq_u32 vcc, 0, v61
s_nop 1
v_cndmask_b32 v16, 0, v64, vcc
v_cndmask_b32 v17, 0, v65, vcc
v_cndmask_b32 v18, 0, v66, vcc
v_cndmask_b32 v19, 0, v67, vcc
v_cmp_eq_u32 vcc, 1, v61
s_nop 1
v_cndmask_b32 v20, 0, v64, vcc
v_cndmask_b32 v21, 0, v65, vcc
v_cndmask_b32 v22, 0, v66, vcc
v_cndmask_b32 v23, 0, v67, vcc
v_cmp_eq_u32 vcc, 2, v61
s_nop 1
v_cndmask_b32 v24, 0, v64, vcc
v_cndmask_b32 v25, 0, v65, vcc
v_cndmask_b32 v26, 0, v66, vcc
v_cndmask_b32 v27, 0, v67, vcc
v_cmp_eq_u32 vcc, 3, v61
s_nop 1
v_cndmask_b32 v28, 0, v64, vcc
v_cndmask_b32 v29, 0, v65, vcc
v_cndmask_b32 v30, 0, v66, vcc
v_cndmask_b32 v31, 0, v67, vcc
s_cmp_gt_u32 s60, 505
s_cselect_b64 vcc, -1, 0
s_nop 1
v_mfma_f32_16x16x32_bf16 v[40:43], v[80:83], v[16:19], 0
v_mfma_f32_16x16x32_bf16 v[40:43], v[84:87], v[20:23], v[40:43]
s_waitcnt lgkmcnt(0)
s_sub_u32 s60, s60, s62
s_cmp_gt_u32 s60, 740
s_cselect_b64 vcc, -1, 0
s_cbranch_vccnz L_fb_32
s_waitcnt vmcnt(4)
L_fb_32:
s_waitcnt vmcnt(6)
buffer_load_dwordx4 v[80:83], v2, s[44:47], s9 offen nt
s_addk_i32 s9, 0x1000
v_mfma_f32_16x16x32_bf16 v[40:43], v[88:91], v[24:27], v[40:43]
v_mfma_f32_16x16x32_bf16 v[40:43], v[92:95], v[28:31], v[40:43]
s_cbranch_vccnz L_fb_33
s_waitcnt vmcnt(4)
L_fb_33:
s_waitcnt vmcnt(6)
buffer_load_dwordx4 v[84:87], v2, s[44:47], s9 offen nt
s_addk_i32 s9, 0x1000
v_mfma_f32_16x16x32_bf16 v[44:47], v[96:99], v[16:19], 0
v_mfma_f32_16x16x32_bf16 v[44:47], v[100:103], v[20:23], v[44:47]
s_cbranch_vccnz L_fb_34
s_waitcnt vmcnt(4)
L_fb_34:
s_waitcnt vmcnt(6)
buffer_load_dwordx4 v[88:91], v2, s[44:47], s9 offen nt
s_addk_i32 s9, 0x1000
v_mfma_f32_16x16x32_bf16 v[44:47], v[104:107], v[24:27], v[44:47]
v_mfma_f32_16x16x32_bf16 v[44:47], v[108:111], v[28:31], v[44:47]
s_cbranch_vccnz L_fb_35
s_waitcnt vmcnt(4)
L_fb_35:
s_waitcnt vmcnt(6)
buffer_load_dwordx4 v[92:95], v2, s[44:47], s9 offen nt
s_addk_i32 s9, 0x1000
v_mfma_f32_16x16x32_bf16 v[48:51], v[112:115], v[16:19], 0
v_mfma_f32_16x16x32_bf16 v[48:51], v[116:119], v[20:23], v[48:51]
s_cbranch_vccnz L_fb_36
s_waitcnt vmcnt(4)
L_fb_36:
s_waitcnt vmcnt(6)
buffer_load_dwordx4 v[96:99], v2, s[44:47], s9 offen nt
s_addk_i32 s9, 0x1000
v_mfma_f32_16x16x32_bf16 v[48:51], v[120:123], v[24:27], v[48:51]
v_mfma_f32_16x16x32_bf16 v[48:51], v[124:127], v[28:31], v[48:51]
s_cbranch_vccnz L_fb_37
s_waitcnt vmcnt(4)
L_fb_37:
s_waitcnt vmcnt(6)
buffer_load_dwordx4 v[100:103], v2, s[44:47], s9 offen nt
s_addk_i32 s9, 0x1000
v_mfma_f32_16x16x32_bf16 v[52:55], v[128:131], v[16:19], 0
v_mfma_f32_16x16x32_bf16 v[52:55], v[132:135], v[20:23], v[52:55]
s_cbranch_vccnz L_fb_38
s_waitcnt vmcnt(4)
L_fb_38:
s_waitcnt vmcnt(6)
buffer_load_dwordx4 v[104:107], v2, s[44:47], s9 offen nt
s_addk_i32 s9, 0x1000
v_mfma_f32_16x16x32_bf16 v[52:55], v[136:139], v[24:27], v[52:55]
v_mfma_f32_16x16x32_bf16 v[52:55], v[140:143], v[28:31], v[52:55]
s_cbranch_vccnz L_fb_39
s_waitcnt vmcnt(4)
L_fb_39:
s_waitcnt vmcnt(6)
buffer_load_dwordx4 v[108:111], v2, s[44:47], s9 offen nt
s_addk_i32 s9, 0x1000
v_mov_b32_dpp v58, v40 quad_perm:[0,0,0,0] row_mask:0xf bank_mask:0xf
v_add_f32_dpp v58, v41, v58 quad_perm:[1,1,1,1] row_mask:0xf bank_mask:0xf
v_add_f32_dpp v58, v42, v58 quad_perm:[2,2,2,2] row_mask:0xf bank_mask:0xf
v_add_f32_dpp v58, v43, v58 quad_perm:[3,3,3,3] row_mask:0xf bank_mask:0xf
v_mov_b32_dpp v59, v44 quad_perm:[0,0,0,0] row_mask:0xf bank_mask:0xf
v_add_f32_dpp v59, v45, v59 quad_perm:[1,1,1,1] row_mask:0xf bank_mask:0xf
v_add_f32_dpp v59, v46, v59 quad_perm:[2,2,2,2] row_mask:0xf bank_mask:0xf
v_add_f32_dpp v59, v47, v59 quad_perm:[3,3,3,3] row_mask:0xf bank_mask:0xf
v_mov_b32_dpp v60, v48 quad_perm:[0,0,0,0] row_mask:0xf bank_mask:0xf
v_add_f32_dpp v60, v49, v60 quad_perm:[1,1,1,1] row_mask:0xf bank_mask:0xf
v_add_f32_dpp v60, v50, v60 quad_perm:[2,2,2,2] row_mask:0xf bank_mask:0xf
v_add_f32_dpp v60, v51, v60 quad_perm:[3,3,3,3] row_mask:0xf bank_mask:0xf
v_mov_b32_dpp v61, v52 quad_perm:[0,0,0,0] row_mask:0xf bank_mask:0xf
v_add_f32_dpp v61, v53, v61 quad_perm:[1,1,1,1] row_mask:0xf bank_mask:0xf
v_add_f32_dpp v61, v54, v61 quad_perm:[2,2,2,2] row_mask:0xf bank_mask:0xf
v_add_f32_dpp v61, v55, v61 quad_perm:[3,3,3,3] row_mask:0xf bank_mask:0xf
v_cndmask_b32 v58, v58, v59, s[96:97]
v_cndmask_b32 v58, v58, v60, s[98:99]
v_cndmask_b32 v58, v58, v61, s[100:101]
v_cvt_pk_bf16_f32 v58, 0, v58
v_mul_f32 v58, s42, v58
v_cvt_pk_bf16_f32 v32, 0, v58
v_mov_b32 v56, v32
v_mfma_f32_16x16x32_bf16 v[40:43], v[144:147], v[16:19], 0
v_mfma_f32_16x16x32_bf16 v[40:43], v[148:151], v[20:23], v[40:43]
s_cbranch_vccnz L_fb_40
s_waitcnt vmcnt(4)
L_fb_40:
s_waitcnt vmcnt(6)
buffer_load_dwordx4 v[112:115], v2, s[44:47], s9 offen nt
s_addk_i32 s9, 0x1000
v_mfma_f32_16x16x32_bf16 v[40:43], v[152:155], v[24:27], v[40:43]
v_mfma_f32_16x16x32_bf16 v[40:43], v[156:159], v[28:31], v[40:43]
s_cbranch_vccnz L_fb_41
s_waitcnt vmcnt(4)
L_fb_41:
s_waitcnt vmcnt(6)
buffer_load_dwordx4 v[116:119], v2, s[44:47], s9 offen nt
s_addk_i32 s9, 0x1000
v_mfma_f32_16x16x32_bf16 v[44:47], v[160:163], v[16:19], 0
v_mfma_f32_16x16x32_bf16 v[44:47], v[164:167], v[20:23], v[44:47]
s_cbranch_vccnz L_fb_42
s_waitcnt vmcnt(4)
L_fb_42:
s_waitcnt vmcnt(6)
buffer_load_dwordx4 v[120:123], v2, s[44:47], s9 offen nt
s_addk_i32 s9, 0x1000
v_mfma_f32_16x16x32_bf16 v[44:47], v[168:171], v[24:27], v[44:47]
v_mfma_f32_16x16x32_bf16 v[44:47], v[172:175], v[28:31], v[44:47]
s_cbranch_vccnz L_fb_43
s_waitcnt vmcnt(4)
L_fb_43:
s_waitcnt vmcnt(6)
buffer_load_dwordx4 v[124:127], v2, s[44:47], s9 offen nt
s_addk_i32 s9, 0x1000
v_mfma_f32_16x16x32_bf16 v[48:51], v[176:179], v[16:19], 0
v_mfma_f32_16x16x32_bf16 v[48:51], v[180:183], v[20:23], v[48:51]
s_memrealtime s[60:61]
s_cbranch_vccnz L_fb_44
s_waitcnt vmcnt(4)
L_fb_44:
s_waitcnt vmcnt(6)
buffer_load_dwordx4 v[128:131], v2, s[44:47], s9 offen nt
s_addk_i32 s9, 0x1000
v_mfma_f32_16x16x32_bf16 v[48:51], v[184:187], v[24:27], v[48:51]
v_mfma_f32_16x16x32_bf16 v[48:51], v[188:191], v[28:31], v[48:51]
s_cbranch_vccnz L_fb_45
s_waitcnt vmcnt(4)
L_fb_45:
s_waitcnt vmcnt(6)
buffer_load_dwordx4 v[132:135], v2, s[44:47], s9 offen nt
s_addk_i32 s9, 0x1000
v_mfma_f32_16x16x32_bf16 v[52:55], v[192:195], v[16:19], 0
v_mfma_f32_16x16x32_bf16 v[52:55], v[196:199], v[20:23], v[52:55]
s_cbranch_vccnz L_fb_46
s_waitcnt vmcnt(4)
L_fb_46:
s_waitcnt vmcnt(6)
buffer_load_dwordx4 v[136:139], v2, s[44:47], s9 offen nt
s_addk_i32 s9, 0x1000
v_mfma_f32_16x16x32_bf16 v[52:55], v[200:203], v[24:27], v[52:55]
v_mfma_f32_16x16x32_bf16 v[52:55], v[204:207], v[28:31], v[52:55]
s_cbranch_vccnz L_fb_47
s_waitcnt vmcnt(4)
L_fb_47:
s_waitcnt vmcnt(6)
buffer_load_dwordx4 v[140:143], v2, s[44:47], s9 offen nt
s_addk_i32 s9, 0x1000
v_mov_b32_dpp v58, v40 quad_perm:[0,0,0,0] row_mask:0xf bank_mask:0xf
v_add_f32_dpp v58, v41, v58 quad_perm:[1,1,1,1] row_mask:0xf bank_mask:0xf
v_add_f32_dpp v58, v42, v58 quad_perm:[2,2,2,2] row_mask:0xf bank_mask:0xf
v_add_f32_dpp v58, v43, v58 quad_perm:[3,3,3,3] row_mask:0xf bank_mask:0xf
v_mov_b32_dpp v59, v44 quad_perm:[0,0,0,0] row_mask:0xf bank_mask:0xf
v_add_f32_dpp v59, v45, v59 quad_perm:[1,1,1,1] row_mask:0xf bank_mask:0xf
v_add_f32_dpp v59, v46, v59 quad_perm:[2,2,2,2] row_mask:0xf bank_mask:0xf
v_add_f32_dpp v59, v47, v59 quad_perm:[3,3,3,3] row_mask:0xf bank_mask:0xf
v_mov_b32_dpp v60, v48 quad_perm:[0,0,0,0] row_mask:0xf bank_mask:0xf
v_add_f32_dpp v60, v49, v60 quad_perm:[1,1,1,1] row_mask:0xf bank_mask:0xf
v_add_f32_dpp v60, v50, v60 quad_perm:[2,2,2,2] row_mask:0xf bank_mask:0xf
v_add_f32_dpp v60, v51, v60 quad_perm:[3,3,3,3] row_mask:0xf bank_mask:0xf
v_mov_b32_dpp v61, v52 quad_perm:[0,0,0,0] row_mask:0xf bank_mask:0xf
v_add_f32_dpp v61, v53, v61 quad_perm:[1,1,1,1] row_mask:0xf bank_mask:0xf
v_add_f32_dpp v61, v54, v61 quad_perm:[2,2,2,2] row_mask:0xf bank_mask:0xf
v_add_f32_dpp v61, v55, v61 quad_perm:[3,3,3,3] row_mask:0xf bank_mask:0xf
v_cndmask_b32 v58, v58, v59, s[96:97]
v_cndmask_b32 v58, v58, v60, s[98:99]
v_cndmask_b32 v58, v58, v61, s[100:101]
v_cvt_pk_bf16_f32 v58, 0, v58
v_mul_f32 v58, s42, v58
v_cvt_pk_bf16_f32 v33, 0, v58
v_max_f32 v56, v56, v33
v_mfma_f32_16x16x32_bf16 v[40:43], v[208:211], v[16:19], 0
v_mfma_f32_16x16x32_bf16 v[40:43], v[212:215], v[20:23], v[40:43]
s_waitcnt lgkmcnt(0)
s_sub_u32 s60, s60, s62
s_cmp_gt_u32 s60, 960
s_cselect_b64 vcc, -1, 0
s_cbranch_vccnz L_fb_48
s_waitcnt vmcnt(4)
L_fb_48:
s_waitcnt vmcnt(6)
buffer_load_dwordx4 v[144:147], v2, s[44:47], s9 offen nt
s_addk_i32 s9, 0x1000
v_mfma_f32_16x16x32_bf16 v[40:43], v[216:219], v[24:27], v[40:43]
v_mfma_f32_16x16x32_bf16 v[40:43], v[220:223], v[28:31], v[40:43]
s_cbranch_vccnz L_fb_49
s_waitcnt vmcnt(4)
L_fb_49:
s_waitcnt vmcnt(6)
buffer_load_dwordx4 v[148:151], v2, s[44:47], s9 offen nt
s_addk_i32 s9, 0x1000
v_mfma_f32_16x16x32_bf16 v[44:47], v[224:227], v[16:19], 0
v_mfma_f32_16x16x32_bf16 v[44:47], v[228:231], v[20:23], v[44:47]
s_cbranch_vccnz L_fb_50
s_waitcnt vmcnt(4)
L_fb_50:
s_waitcnt vmcnt(6)
buffer_load_dwordx4 v[152:155], v2, s[44:47], s9 offen nt
s_addk_i32 s9, 0x1000
v_mfma_f32_16x16x32_bf16 v[44:47], v[232:235], v[24:27], v[44:47]
v_mfma_f32_16x16x32_bf16 v[44:47], v[236:239], v[28:31], v[44:47]
s_cbranch_vccnz L_fb_51
s_waitcnt vmcnt(4)
L_fb_51:
s_waitcnt vmcnt(6)
buffer_load_dwordx4 v[156:159], v2, s[44:47], s9 offen nt
s_addk_i32 s9, 0x1000
v_mfma_f32_16x16x32_bf16 v[48:51], v[240:243], v[16:19], 0
v_mfma_f32_16x16x32_bf16 v[48:51], v[244:247], v[20:23], v[48:51]
s_cbranch_vccnz L_fb_52
s_waitcnt vmcnt(4)
L_fb_52:
s_waitcnt vmcnt(6)
buffer_load_dwordx4 v[160:163], v2, s[44:47], s9 offen nt
s_addk_i32 s9, 0x1000
v_mfma_f32_16x16x32_bf16 v[48:51], v[248:251], v[24:27], v[48:51]
v_mfma_f32_16x16x32_bf16 v[48:51], v[252:255], v[28:31], v[48:51]
s_cbranch_vccnz L_fb_53
s_waitcnt vmcnt(4)
L_fb_53:
s_waitcnt vmcnt(6)
buffer_load_dwordx4 v[164:167], v2, s[44:47], s9 offen nt
s_addk_i32 s9, 0x1000
v_mfma_f32_16x16x32_bf16 v[52:55], v[80:83], v[16:19], 0
v_mfma_f32_16x16x32_bf16 v[52:55], v[84:87], v[20:23], v[52:55]
s_cbranch_vccnz L_fb_54
s_waitcnt vmcnt(4)
L_fb_54:
s_waitcnt vmcnt(6)
buffer_load_dwordx4 v[168:171], v2, s[44:47], s9 offen nt
s_addk_i32 s9, 0x1000
v_mfma_f32_16x16x32_bf16 v[52:55], v[88:91], v[24:27], v[52:55]
v_mfma_f32_16x16x32_bf16 v[52:55], v[92:95], v[28:31], v[52:55]
s_cbranch_vccnz L_fb_55
s_waitcnt vmcnt(4)
L_fb_55:
s_waitcnt vmcnt(6)
buffer_load_dwordx4 v[172:175], v2, s[44:47], s9 offen nt
s_addk_i32 s9, 0x1000
v_mov_b32_dpp v58, v40 quad_perm:[0,0,0,0] row_mask:0xf bank_mask:0xf
v_add_f32_dpp v58, v41, v58 quad_perm:[1,1,1,1] row_mask:0xf bank_mask:0xf
v_add_f32_dpp v58, v42, v58 quad_perm:[2,2,2,2] row_mask:0xf bank_mask:0xf
v_add_f32_dpp v58, v43, v58 quad_perm:[3,3,3,3] row_mask:0xf bank_mask:0xf
v_mov_b32_dpp v59, v44 quad_perm:[0,0,0,0] row_mask:0xf bank_mask:0xf
v_add_f32_dpp v59, v45, v59 quad_perm:[1,1,1,1] row_mask:0xf bank_mask:0xf
v_add_f32_dpp v59, v46, v59 quad_perm:[2,2,2,2] row_mask:0xf bank_mask:0xf
v_add_f32_dpp v59, v47, v59 quad_perm:[3,3,3,3] row_mask:0xf bank_mask:0xf
v_mov_b32_dpp v60, v48 quad_perm:[0,0,0,0] row_mask:0xf bank_mask:0xf
v_add_f32_dpp v60, v49, v60 quad_perm:[1,1,1,1] row_mask:0xf bank_mask:0xf
v_add_f32_dpp v60, v50, v60 quad_perm:[2,2,2,2] row_mask:0xf bank_mask:0xf
v_add_f32_dpp v60, v51, v60 quad_perm:[3,3,3,3] row_mask:0xf bank_mask:0xf
v_mov_b32_dpp v61, v52 quad_perm:[0,0,0,0] row_mask:0xf bank_mask:0xf
v_add_f32_dpp v61, v53, v61 quad_perm:[1,1,1,1] row_mask:0xf bank_mask:0xf
v_add_f32_dpp v61, v54, v61 quad_perm:[2,2,2,2] row_mask:0xf bank_mask:0xf
v_add_f32_dpp v61, v55, v61 quad_perm:[3,3,3,3] row_mask:0xf bank_mask:0xf
v_cndmask_b32 v58, v58, v59, s[96:97]
v_cndmask_b32 v58, v58, v60, s[98:99]
v_cndmask_b32 v58, v58, v61, s[100:101]
v_cvt_pk_bf16_f32 v58, 0, v58
v_mul_f32 v58, s42, v58
v_cvt_pk_bf16_f32 v34, 0, v58
v_max_f32 v56, v56, v34
v_mfma_f32_16x16x32_bf16 v[40:43], v[96:99], v[16:19], 0
v_mfma_f32_16x16x32_bf16 v[40:43], v[100:103], v[20:23], v[40:43]
s_cbranch_vccnz L_fb_56
s_waitcnt vmcnt(4)
L_fb_56:
s_waitcnt vmcnt(6)
buffer_load_dwordx4 v[176:179], v2, s[44:47], s9 offen nt
s_addk_i32 s9, 0x1000
v_mfma_f32_16x16x32_bf16 v[40:43], v[104:107], v[24:27], v[40:43]
v_mfma_f32_16x16x32_bf16 v[40:43], v[108:111], v[28:31], v[40:43]
s_cbranch_vccnz L_fb_57
s_waitcnt vmcnt(4)
L_fb_57:
s_waitcnt vmcnt(6)
buffer_load_dwordx4 v[180:183], v2, s[44:47], s9 offen nt
s_addk_i32 s9, 0x1000
v_mfma_f32_16x16x32_bf16 v[44:47], v[112:115], v[16:19], 0
v_mfma_f32_16x16x32_bf16 v[44:47], v[116:119], v[20:23], v[44:47]
s_cbranch_vccnz L_fb_58
s_waitcnt vmcnt(4)
L_fb_58:
s_waitcnt vmcnt(6)
buffer_load_dwordx4 v[184:187], v2, s[44:47], s9 offen nt
s_addk_i32 s9, 0x1000
v_mfma_f32_16x16x32_bf16 v[44:47], v[120:123], v[24:27], v[44:47]
v_mfma_f32_16x16x32_bf16 v[44:47], v[124:127], v[28:31], v[44:47]
s_cbranch_vccnz L_fb_59
s_waitcnt vmcnt(4)
L_fb_59:
s_waitcnt vmcnt(6)
buffer_load_dwordx4 v[188:191], v2, s[44:47], s9 offen nt
s_addk_i32 s9, 0x1000
v_mfma_f32_16x16x32_bf16 v[48:51], v[128:131], v[16:19], 0
v_mfma_f32_16x16x32_bf16 v[48:51], v[132:135], v[20:23], v[48:51]
s_memrealtime s[60:61]
s_cbranch_vccnz L_fb_60
s_waitcnt vmcnt(4)
L_fb_60:
s_waitcnt vmcnt(6)
buffer_load_dwordx4 v[192:195], v2, s[44:47], s9 offen nt
s_addk_i32 s9, 0x1000
v_mfma_f32_16x16x32_bf16 v[48:51], v[136:139], v[24:27], v[48:51]
v_mfma_f32_16x16x32_bf16 v[48:51], v[140:143], v[28:31], v[48:51]
s_cbranch_vccnz L_fb_61
s_waitcnt vmcnt(4)
L_fb_61:
s_waitcnt vmcnt(6)
buffer_load_dwordx4 v[196:199], v2, s[44:47], s9 offen nt
s_addk_i32 s9, 0x1000
v_mfma_f32_16x16x32_bf16 v[52:55], v[144:147], v[16:19], 0
v_mfma_f32_16x16x32_bf16 v[52:55], v[148:151], v[20:23], v[52:55]
s_cbranch_vccnz L_fb_62
s_waitcnt vmcnt(4)
L_fb_62:
s_waitcnt vmcnt(6)
buffer_load_dwordx4 v[200:203], v2, s[44:47], s9 offen nt
s_addk_i32 s9, 0x1000
v_mfma_f32_16x16x32_bf16 v[52:55], v[152:155], v[24:27], v[52:55]
s_cbranch_vccnz L_fb_63
s_waitcnt vmcnt(4)
L_fb_63:
s_waitcnt vmcnt(6)
buffer_load_dwordx4 v[204:207], v2, s[44:47], s9 offen nt
s_addk_i32 s9, 0x1000
v_mfma_f32_16x16x32_bf16 v[52:55], v[156:159], v[28:31], v[52:55]
s_waitcnt lgkmcnt(0)
s_sub_u32 s60, s60, s62
s_cmp_gt_u32 s60, 1180
s_cselect_b64 vcc, -1, 0
s_cbranch_vccnz L_fb_64
s_waitcnt vmcnt(4)
L_fb_64:
s_waitcnt vmcnt(6)
buffer_load_dwordx4 v[208:211], v2, s[44:47], s9 offen nt
s_addk_i32 s9, 0x1000
v_mov_b32_dpp v58, v40 quad_perm:[0,0,0,0] row_mask:0xf bank_mask:0xf
v_add_f32_dpp v58, v41, v58 quad_perm:[1,1,1,1] row_mask:0xf bank_mask:0xf
v_add_f32_dpp v58, v42, v58 quad_perm:[2,2,2,2] row_mask:0xf bank_mask:0xf
v_add_f32_dpp v58, v43, v58 quad_perm:[3,3,3,3] row_mask:0xf bank_mask:0xf
v_mov_b32_dpp v59, v44 quad_perm:[0,0,0,0] row_mask:0xf bank_mask:0xf
v_add_f32_dpp v59, v45, v59 quad_perm:[1,1,1,1] row_mask:0xf bank_mask:0xf
v_add_f32_dpp v59, v46, v59 quad_perm:[2,2,2,2] row_mask:0xf bank_mask:0xf
v_add_f32_dpp v59, v47, v59 quad_perm:[3,3,3,3] row_mask:0xf bank_mask:0xf
v_mov_b32_dpp v60, v48 quad_perm:[0,0,0,0] row_mask:0xf bank_mask:0xf
v_add_f32_dpp v60, v49, v60 quad_perm:[1,1,1,1] row_mask:0xf bank_mask:0xf
v_add_f32_dpp v60, v50, v60 quad_perm:[2,2,2,2] row_mask:0xf bank_mask:0xf
v_add_f32_dpp v60, v51, v60 quad_perm:[3,3,3,3] row_mask:0xf bank_mask:0xf
v_mov_b32_dpp v61, v52 quad_perm:[0,0,0,0] row_mask:0xf bank_mask:0xf
v_add_f32_dpp v61, v53, v61 quad_perm:[1,1,1,1] row_mask:0xf bank_mask:0xf
v_add_f32_dpp v61, v54, v61 quad_perm:[2,2,2,2] row_mask:0xf bank_mask:0xf
v_add_f32_dpp v61, v55, v61 quad_perm:[3,3,3,3] row_mask:0xf bank_mask:0xf
v_cndmask_b32 v58, v58, v59, s[96:97]
v_cndmask_b32 v58, v58, v60, s[98:99]
v_cndmask_b32 v58, v58, v61, s[100:101]
v_cvt_pk_bf16_f32 v58, 0, v58
v_mul_f32 v58, s42, v58
v_cvt_pk_bf16_f32 v35, 0, v58
v_max_f32 v56, v56, v35
v_mfma_f32_16x16x32_bf16 v[40:43], v[160:163], v[16:19], 0
s_cbranch_vccnz L_fb_65
s_waitcnt vmcnt(4)
L_fb_65:
s_waitcnt vmcnt(6)
buffer_load_dwordx4 v[212:215], v2, s[44:47], s9 offen nt
s_addk_i32 s9, 0x1000
v_mfma_f32_16x16x32_bf16 v[40:43], v[164:167], v[20:23], v[40:43]
s_cbranch_vccnz L_fb_66
s_waitcnt vmcnt(4)
L_fb_66:
s_waitcnt vmcnt(6)
buffer_load_dwordx4 v[216:219], v2, s[44:47], s9 offen nt
s_addk_i32 s9, 0x1000
v_mfma_f32_16x16x32_bf16 v[40:43], v[168:171], v[24:27], v[40:43]
s_cbranch_vccnz L_fb_67
s_waitcnt vmcnt(4)
L_fb_67:
s_waitcnt vmcnt(6)
buffer_load_dwordx4 v[220:223], v2, s[44:47], s9 offen nt
s_addk_i32 s9, 0x1000
v_mfma_f32_16x16x32_bf16 v[40:43], v[172:175], v[28:31], v[40:43]
s_cbranch_vccnz L_fb_68
s_waitcnt vmcnt(4)
L_fb_68:
s_waitcnt vmcnt(6)
buffer_load_dwordx4 v[224:227], v2, s[44:47], s9 offen nt
s_addk_i32 s9, 0x1000
v_mfma_f32_16x16x32_bf16 v[44:47], v[176:179], v[16:19], 0
s_cbranch_vccnz L_fb_69
s_waitcnt vmcnt(4)
L_fb_69:
s_waitcnt vmcnt(6)
buffer_load_dwordx4 v[228:231], v2, s[44:47], s9 offen nt
s_addk_i32 s9, 0x1000
v_mfma_f32_16x16x32_bf16 v[44:47], v[180:183], v[20:23], v[44:47]
s_cbranch_vccnz L_fb_70
s_waitcnt vmcnt(4)
L_fb_70:
s_waitcnt vmcnt(6)
buffer_load_dwordx4 v[232:235], v2, s[44:47], s9 offen nt
s_addk_i32 s9, 0x1000
v_mfma_f32_16x16x32_bf16 v[44:47], v[184:187], v[24:27], v[44:47]
s_cbranch_vccnz L_fb_71
s_waitcnt vmcnt(4)
L_fb_71:
s_waitcnt vmcnt(6)
buffer_load_dwordx4 v[236:239], v2, s[44:47], s9 offen nt
s_addk_i32 s9, 0x1000
v_mfma_f32_16x16x32_bf16 v[44:47], v[188:191], v[28:31], v[44:47]
s_cbranch_vccnz L_fb_72
s_waitcnt vmcnt(4)
L_fb_72:
s_waitcnt vmcnt(6)
buffer_load_dwordx4 v[240:243], v2, s[44:47], s9 offen nt
s_addk_i32 s9, 0x1000
v_mfma_f32_16x16x32_bf16 v[48:51], v[192:195], v[16:19], 0
s_cbranch_vccnz L_fb_73
s_waitcnt vmcnt(4)
L_fb_73:
s_waitcnt vmcnt(6)
buffer_load_dwordx4 v[244:247], v2, s[44:47], s9 offen nt
s_addk_i32 s9, 0x1000
v_mfma_f32_16x16x32_bf16 v[48:51], v[196:199], v[20:23], v[48:51]
s_cbranch_vccnz L_fb_74
s_waitcnt vmcnt(4)
L_fb_74:
s_waitcnt vmcnt(6)
buffer_load_dwordx4 v[248:251], v2, s[44:47], s9 offen nt
s_addk_i32 s9, 0x1000
v_mfma_f32_16x16x32_bf16 v[48:51], v[200:203], v[24:27], v[48:51]
s_cbranch_vccnz L_fb_75
s_waitcnt vmcnt(4)
L_fb_75:
s_waitcnt vmcnt(6)
buffer_load_dwordx4 v[252:255], v2, s[44:47], s9 offen nt
s_addk_i32 s9, 0x1000
v_mfma_f32_16x16x32_bf16 v[48:51], v[204:207], v[28:31], v[48:51]
s_memrealtime s[60:61]
s_cbranch_vccnz L_fb_76
s_waitcnt vmcnt(4)
L_fb_76:
s_waitcnt vmcnt(6)
buffer_load_dwordx4 v[80:83], v2, s[44:47], s9 offen nt
s_addk_i32 s9, 0x1000
v_mfma_f32_16x16x32_bf16 v[52:55], v[208:211], v[16:19], 0
s_cbranch_vccnz L_fb_77
s_waitcnt vmcnt(4)
L_fb_77:
s_waitcnt vmcnt(6)
buffer_load_dwordx4 v[84:87], v2, s[44:47], s9 offen nt
s_addk_i32 s9, 0x1000
v_mfma_f32_16x16x32_bf16 v[52:55], v[212:215], v[20:23], v[52:55]
s_cbranch_vccnz L_fb_78
s_waitcnt vmcnt(4)
L_fb_78:
s_waitcnt vmcnt(6)
buffer_load_dwordx4 v[88:91], v2, s[44:47], s9 offen nt
s_addk_i32 s9, 0x1000
v_mfma_f32_16x16x32_bf16 v[52:55], v[216:219], v[24:27], v[52:55]
s_cbranch_vccnz L_fb_79
s_waitcnt vmcnt(4)
L_fb_79:
s_waitcnt vmcnt(6)
buffer_load_dwordx4 v[92:95], v2, s[44:47], s9 offen nt
s_addk_i32 s9, 0x1000
v_mfma_f32_16x16x32_bf16 v[52:55], v[220:223], v[28:31], v[52:55]
s_waitcnt lgkmcnt(0)
s_sub_u32 s60, s60, s62
s_cmp_gt_u32 s60, 1400
s_cselect_b64 vcc, -1, 0
s_cbranch_vccnz L_fb_80
s_waitcnt vmcnt(4)
L_fb_80:
s_waitcnt vmcnt(6)
buffer_load_dwordx4 v[96:99], v2, s[44:47], s9 offen nt
s_addk_i32 s9, 0x1000
v_mov_b32_dpp v58, v40 quad_perm:[0,0,0,0] row_mask:0xf bank_mask:0xf
v_add_f32_dpp v58, v41, v58 quad_perm:[1,1,1,1] row_mask:0xf bank_mask:0xf
v_add_f32_dpp v58, v42, v58 quad_perm:[2,2,2,2] row_mask:0xf bank_mask:0xf
v_add_f32_dpp v58, v43, v58 quad_perm:[3,3,3,3] row_mask:0xf bank_mask:0xf
v_mov_b32_dpp v59, v44 quad_perm:[0,0,0,0] row_mask:0xf bank_mask:0xf
v_add_f32_dpp v59, v45, v59 quad_perm:[1,1,1,1] row_mask:0xf bank_mask:0xf
v_add_f32_dpp v59, v46, v59 quad_perm:[2,2,2,2] row_mask:0xf bank_mask:0xf
v_add_f32_dpp v59, v47, v59 quad_perm:[3,3,3,3] row_mask:0xf bank_mask:0xf
v_mov_b32_dpp v60, v48 quad_perm:[0,0,0,0] row_mask:0xf bank_mask:0xf
v_add_f32_dpp v60, v49, v60 quad_perm:[1,1,1,1] row_mask:0xf bank_mask:0xf
v_add_f32_dpp v60, v50, v60 quad_perm:[2,2,2,2] row_mask:0xf bank_mask:0xf
v_add_f32_dpp v60, v51, v60 quad_perm:[3,3,3,3] row_mask:0xf bank_mask:0xf
v_mov_b32_dpp v61, v52 quad_perm:[0,0,0,0] row_mask:0xf bank_mask:0xf
v_add_f32_dpp v61, v53, v61 quad_perm:[1,1,1,1] row_mask:0xf bank_mask:0xf
v_add_f32_dpp v61, v54, v61 quad_perm:[2,2,2,2] row_mask:0xf bank_mask:0xf
v_add_f32_dpp v61, v55, v61 quad_perm:[3,3,3,3] row_mask:0xf bank_mask:0xf
v_cndmask_b32 v58, v58, v59, s[96:97]
v_cndmask_b32 v58, v58, v60, s[98:99]
v_cndmask_b32 v58, v58, v61, s[100:101]
v_cvt_pk_bf16_f32 v58, 0, v58
v_mul_f32 v58, s42, v58
v_cvt_pk_bf16_f32 v36, 0, v58
ds_write_b32 v57, v57 offset:288
v_max_f32 v56, v56, v36
v_mfma_f32_16x16x32_bf16 v[40:43], v[224:227], v[16:19], 0
s_cbranch_vccnz L_fb_81
s_waitcnt vmcnt(4)
L_fb_81:
s_waitcnt vmcnt(6)
buffer_load_dwordx4 v[100:103], v2, s[44:47], s9 offen nt
s_addk_i32 s9, 0x1000
v_mfma_f32_16x16x32_bf16 v[40:43], v[228:231], v[20:23], v[40:43]
s_cbranch_vccnz L_fb_82
s_waitcnt vmcnt(4)
L_fb_82:
s_waitcnt vmcnt(6)
buffer_load_dwordx4 v[104:107], v2, s[44:47], s9 offen nt
s_addk_i32 s9, 0x1000
v_mfma_f32_16x16x32_bf16 v[40:43], v[232:235], v[24:27], v[40:43]
s_cbranch_vccnz L_fb_83
s_waitcnt vmcnt(4)
L_fb_83:
s_waitcnt vmcnt(6)
buffer_load_dwordx4 v[108:111], v2, s[44:47], s9 offen nt
s_addk_i32 s9, 0x1000
v_mfma_f32_16x16x32_bf16 v[40:43], v[236:239], v[28:31], v[40:43]
s_cbranch_vccnz L_fb_84
s_waitcnt vmcnt(4)
L_fb_84:
s_waitcnt vmcnt(6)
buffer_load_dwordx4 v[112:115], v2, s[44:47], s9 offen nt
s_addk_i32 s9, 0x1000
v_mfma_f32_16x16x32_bf16 v[44:47], v[240:243], v[16:19], 0
s_cbranch_vccnz L_fb_85
s_waitcnt vmcnt(4)
L_fb_85:
s_waitcnt vmcnt(6)
buffer_load_dwordx4 v[116:119], v2, s[44:47], s9 offen nt
s_addk_i32 s9, 0x1000
v_mfma_f32_16x16x32_bf16 v[44:47], v[244:247], v[20:23], v[44:47]
s_cbranch_vccnz L_fb_86
s_waitcnt vmcnt(4)
L_fb_86:
s_waitcnt vmcnt(6)
buffer_load_dwordx4 v[120:123], v2, s[44:47], s9 offen nt
s_addk_i32 s9, 0x1000
v_mfma_f32_16x16x32_bf16 v[44:47], v[248:251], v[24:27], v[44:47]
s_cbranch_vccnz L_fb_87
s_waitcnt vmcnt(4)
L_fb_87:
s_waitcnt vmcnt(6)
buffer_load_dwordx4 v[124:127], v2, s[44:47], s9 offen nt
s_addk_i32 s9, 0x1000
v_mfma_f32_16x16x32_bf16 v[44:47], v[252:255], v[28:31], v[44:47]
s_cbranch_vccnz L_fb_88
s_waitcnt vmcnt(4)
L_fb_88:
s_waitcnt vmcnt(6)
buffer_load_dwordx4 v[128:131], v2, s[44:47], s9 offen nt
s_addk_i32 s9, 0x1000
v_mfma_f32_16x16x32_bf16 v[48:51], v[80:83], v[16:19], 0
s_cbranch_vccnz L_fb_89
s_waitcnt vmcnt(4)
L_fb_89:
s_waitcnt vmcnt(6)
buffer_load_dwordx4 v[132:135], v2, s[44:47], s9 offen nt
s_addk_i32 s9, 0x1000
v_mfma_f32_16x16x32_bf16 v[48:51], v[84:87], v[20:23], v[48:51]
s_cbranch_vccnz L_fb_90
s_waitcnt vmcnt(4)
L_fb_90:
s_waitcnt vmcnt(6)
buffer_load_dwordx4 v[136:139], v2, s[44:47], s9 offen nt
s_addk_i32 s9, 0x1000
v_mfma_f32_16x16x32_bf16 v[48:51], v[88:91], v[24:27], v[48:51]
s_cbranch_vccnz L_fb_91
s_waitcnt vmcnt(4)
L_fb_91:
s_waitcnt vmcnt(6)
buffer_load_dwordx4 v[140:143], v2, s[44:47], s9 offen nt
s_addk_i32 s9, 0x1000
v_mfma_f32_16x16x32_bf16 v[48:51], v[92:95], v[28:31], v[48:51]
s_memrealtime s[60:61]
s_cbranch_vccnz L_fb_92
s_waitcnt vmcnt(4)
L_fb_92:
s_waitcnt vmcnt(6)
buffer_load_dwordx4 v[144:147], v2, s[44:47], s9 offen nt
s_addk_i32 s9, 0x1000
v_mfma_f32_16x16x32_bf16 v[52:55], v[96:99], v[16:19], 0
s_cbranch_vccnz L_fb_93
s_waitcnt vmcnt(4)
L_fb_93:
s_waitcnt vmcnt(6)
buffer_load_dwordx4 v[148:151], v2, s[44:47], s9 offen nt
s_addk_i32 s9, 0x1000
v_mfma_f32_16x16x32_bf16 v[52:55], v[100:103], v[20:23], v[52:55]
s_cbranch_vccnz L_fb_94
s_waitcnt vmcnt(4)
L_fb_94:
s_waitcnt vmcnt(6)
buffer_load_dwordx4 v[152:155], v2, s[44:47], s9 offen nt
s_addk_i32 s9, 0x1000
v_mfma_f32_16x16x32_bf16 v[52:55], v[104:107], v[24:27], v[52:55]
s_cbranch_vccnz L_fb_95
s_waitcnt vmcnt(4)
L_fb_95:
s_waitcnt vmcnt(6)
buffer_load_dwordx4 v[156:159], v2, s[44:47], s9 offen nt
s_addk_i32 s9, 0x1000
v_mfma_f32_16x16x32_bf16 v[52:55], v[108:111], v[28:31], v[52:55]
s_waitcnt lgkmcnt(0)
s_sub_u32 s60, s60, s62
s_cmp_gt_u32 s60, 1630
s_cselect_b64 vcc, -1, 0
s_cbranch_vccnz L_fb_96
s_waitcnt vmcnt(4)
L_fb_96:
s_waitcnt vmcnt(6)
buffer_load_dwordx4 v[160:163], v2, s[44:47], s9 offen nt
s_addk_i32 s9, 0x1000
v_mov_b32_dpp v58, v40 quad_perm:[0,0,0,0] row_mask:0xf bank_mask:0xf
v_add_f32_dpp v58, v41, v58 quad_perm:[1,1,1,1] row_mask:0xf bank_mask:0xf
v_add_f32_dpp v58, v42, v58 quad_perm:[2,2,2,2] row_mask:0xf bank_mask:0xf
v_add_f32_dpp v58, v43, v58 quad_perm:[3,3,3,3] row_mask:0xf bank_mask:0xf
v_mov_b32_dpp v59, v44 quad_perm:[0,0,0,0] row_mask:0xf bank_mask:0xf
v_add_f32_dpp v59, v45, v59 quad_perm:[1,1,1,1] row_mask:0xf bank_mask:0xf
v_add_f32_dpp v59, v46, v59 quad_perm:[2,2,2,2] row_mask:0xf bank_mask:0xf
v_add_f32_dpp v59, v47, v59 quad_perm:[3,3,3,3] row_mask:0xf bank_mask:0xf
v_mov_b32_dpp v60, v48 quad_perm:[0,0,0,0] row_mask:0xf bank_mask:0xf
v_add_f32_dpp v60, v49, v60 quad_perm:[1,1,1,1] row_mask:0xf bank_mask:0xf
v_add_f32_dpp v60, v50, v60 quad_perm:[2,2,2,2] row_mask:0xf bank_mask:0xf
v_add_f32_dpp v60, v51, v60 quad_perm:[3,3,3,3] row_mask:0xf bank_mask:0xf
v_mov_b32_dpp v61, v52 quad_perm:[0,0,0,0] row_mask:0xf bank_mask:0xf
v_add_f32_dpp v61, v53, v61 quad_perm:[1,1,1,1] row_mask:0xf bank_mask:0xf
v_add_f32_dpp v61, v54, v61 quad_perm:[2,2,2,2] row_mask:0xf bank_mask:0xf
v_add_f32_dpp v61, v55, v61 quad_perm:[3,3,3,3] row_mask:0xf bank_mask:0xf
v_cndmask_b32 v58, v58, v59, s[96:97]
v_cndmask_b32 v58, v58, v60, s[98:99]
v_cndmask_b32 v58, v58, v61, s[100:101]
v_cvt_pk_bf16_f32 v58, 0, v58
v_mul_f32 v58, s42, v58
v_cvt_pk_bf16_f32 v37, 0, v58
v_max_f32 v56, v56, v37
v_mfma_f32_16x16x32_bf16 v[40:43], v[112:115], v[16:19], 0
s_cbranch_vccnz L_fb_97
s_waitcnt vmcnt(4)
L_fb_97:
s_waitcnt vmcnt(6)
buffer_load_dwordx4 v[164:167], v2, s[44:47], s9 offen nt
s_addk_i32 s9, 0x1000
v_mfma_f32_16x16x32_bf16 v[40:43], v[116:119], v[20:23], v[40:43]
s_cbranch_vccnz L_fb_98
s_waitcnt vmcnt(4)
L_fb_98:
s_waitcnt vmcnt(6)
buffer_load_dwordx4 v[168:171], v2, s[44:47], s9 offen nt
s_addk_i32 s9, 0x1000
v_mfma_f32_16x16x32_bf16 v[40:43], v[120:123], v[24:27], v[40:43]
s_cbranch_vccnz L_fb_99
s_waitcnt vmcnt(4)
L_fb_99:
s_waitcnt vmcnt(6)
buffer_load_dwordx4 v[172:175], v2, s[44:47], s9 offen nt
s_addk_i32 s9, 0x1000
v_mfma_f32_16x16x32_bf16 v[40:43], v[124:127], v[28:31], v[40:43]
s_cbranch_vccnz L_fb_100
s_waitcnt vmcnt(4)
L_fb_100:
s_waitcnt vmcnt(6)
buffer_load_dwordx4 v[176:179], v2, s[44:47], s9 offen nt
s_addk_i32 s9, 0x1000
v_mfma_f32_16x16x32_bf16 v[44:47], v[128:131], v[16:19], 0
s_cbranch_vccnz L_fb_101
s_waitcnt vmcnt(4)
L_fb_101:
s_waitcnt vmcnt(6)
buffer_load_dwordx4 v[180:183], v2, s[44:47], s9 offen nt
s_addk_i32 s9, 0x1000
v_mfma_f32_16x16x32_bf16 v[44:47], v[132:135], v[20:23], v[44:47]
s_cbranch_vccnz L_fb_102
s_waitcnt vmcnt(4)
L_fb_102:
s_waitcnt vmcnt(6)
buffer_load_dwordx4 v[184:187], v2, s[44:47], s9 offen nt
s_addk_i32 s9, 0x1000
v_mfma_f32_16x16x32_bf16 v[44:47], v[136:139], v[24:27], v[44:47]
s_cbranch_vccnz L_fb_103
s_waitcnt vmcnt(4)
L_fb_103:
s_waitcnt vmcnt(6)
buffer_load_dwordx4 v[188:191], v2, s[44:47], s9 offen nt
s_addk_i32 s9, 0x1000
v_mfma_f32_16x16x32_bf16 v[44:47], v[140:143], v[28:31], v[44:47]
s_cbranch_vccnz L_fb_104
s_waitcnt vmcnt(4)
L_fb_104:
s_waitcnt vmcnt(6)
buffer_load_dwordx4 v[192:195], v2, s[44:47], s9 offen nt
s_addk_i32 s9, 0x1000
v_mfma_f32_16x16x32_bf16 v[48:51], v[144:147], v[16:19], 0
s_cbranch_vccnz L_fb_105
s_waitcnt vmcnt(4)
L_fb_105:
s_waitcnt vmcnt(6)
buffer_load_dwordx4 v[196:199], v2, s[44:47], s9 offen nt
s_addk_i32 s9, 0x1000
v_mfma_f32_16x16x32_bf16 v[48:51], v[148:151], v[20:23], v[48:51]
s_cbranch_vccnz L_fb_106
s_waitcnt vmcnt(4)
L_fb_106:
s_waitcnt vmcnt(6)
buffer_load_dwordx4 v[200:203], v2, s[44:47], s9 offen nt
s_addk_i32 s9, 0x1000
v_mfma_f32_16x16x32_bf16 v[48:51], v[152:155], v[24:27], v[48:51]
s_cbranch_vccnz L_fb_107
s_waitcnt vmcnt(4)
L_fb_107:
s_waitcnt vmcnt(6)
buffer_load_dwordx4 v[204:207], v2, s[44:47], s9 offen nt
s_addk_i32 s9, 0x1000
v_mfma_f32_16x16x32_bf16 v[48:51], v[156:159], v[28:31], v[48:51]
s_memrealtime s[60:61]
s_cbranch_vccnz L_fb_108
s_waitcnt vmcnt(4)
L_fb_108:
s_waitcnt vmcnt(6)
buffer_load_dwordx4 v[208:211], v2, s[44:47], s9 offen nt
s_addk_i32 s9, 0x1000
v_mfma_f32_16x16x32_bf16 v[52:55], v[160:163], v[16:19], 0
s_cbranch_vccnz L_fb_109
s_waitcnt vmcnt(4)
L_fb_109:
s_waitcnt vmcnt(6)
buffer_load_dwordx4 v[212:215], v2, s[44:47], s9 offen nt
s_addk_i32 s9, 0x1000
v_mfma_f32_16x16x32_bf16 v[52:55], v[164:167], v[20:23], v[52:55]
s_cbranch_vccnz L_fb_110
s_waitcnt vmcnt(4)
L_fb_110:
s_waitcnt vmcnt(6)
buffer_load_dwordx4 v[216:219], v2, s[44:47], s9 offen nt
s_addk_i32 s9, 0x1000
v_mfma_f32_16x16x32_bf16 v[52:55], v[168:171], v[24:27], v[52:55]
s_cbranch_vccnz L_fb_111
s_waitcnt vmcnt(4)
L_fb_111:
s_waitcnt vmcnt(6)
buffer_load_dwordx4 v[220:223], v2, s[44:47], s9 offen nt
s_addk_i32 s9, 0x1000
v_mfma_f32_16x16x32_bf16 v[52:55], v[172:175], v[28:31], v[52:55]
s_waitcnt lgkmcnt(0)
s_sub_u32 s60, s60, s62
s_cmp_gt_u32 s60, 1865
s_cselect_b64 vcc, -1, 0
s_cbranch_vccnz L_fb_112
s_waitcnt vmcnt(4)
L_fb_112:
s_waitcnt vmcnt(6)
buffer_load_dwordx4 v[224:227], v2, s[44:47], s9 offen nt
s_addk_i32 s9, 0x1000
v_mov_b32_dpp v58, v40 quad_perm:[0,0,0,0] row_mask:0xf bank_mask:0xf
v_add_f32_dpp v58, v41, v58 quad_perm:[1,1,1,1] row_mask:0xf bank_mask:0xf
v_add_f32_dpp v58, v42, v58 quad_perm:[2,2,2,2] row_mask:0xf bank_mask:0xf
v_add_f32_dpp v58, v43, v58 quad_perm:[3,3,3,3] row_mask:0xf bank_mask:0xf
v_mov_b32_dpp v59, v44 quad_perm:[0,0,0,0] row_mask:0xf bank_mask:0xf
v_add_f32_dpp v59, v45, v59 quad_perm:[1,1,1,1] row_mask:0xf bank_mask:0xf
v_add_f32_dpp v59, v46, v59 quad_perm:[2,2,2,2] row_mask:0xf bank_mask:0xf
v_add_f32_dpp v59, v47, v59 quad_perm:[3,3,3,3] row_mask:0xf bank_mask:0xf
v_mov_b32_dpp v60, v48 quad_perm:[0,0,0,0] row_mask:0xf bank_mask:0xf
v_add_f32_dpp v60, v49, v60 quad_perm:[1,1,1,1] row_mask:0xf bank_mask:0xf
v_add_f32_dpp v60, v50, v60 quad_perm:[2,2,2,2] row_mask:0xf bank_mask:0xf
v_add_f32_dpp v60, v51, v60 quad_perm:[3,3,3,3] row_mask:0xf bank_mask:0xf
v_mov_b32_dpp v61, v52 quad_perm:[0,0,0,0] row_mask:0xf bank_mask:0xf
v_add_f32_dpp v61, v53, v61 quad_perm:[1,1,1,1] row_mask:0xf bank_mask:0xf
v_add_f32_dpp v61, v54, v61 quad_perm:[2,2,2,2] row_mask:0xf bank_mask:0xf
v_add_f32_dpp v61, v55, v61 quad_perm:[3,3,3,3] row_mask:0xf bank_mask:0xf
v_cndmask_b32 v58, v58, v59, s[96:97]
v_cndmask_b32 v58, v58, v60, s[98:99]
v_cndmask_b32 v58, v58, v61, s[100:101]
v_cvt_pk_bf16_f32 v58, 0, v58
v_mul_f32 v58, s42, v58
v_cvt_pk_bf16_f32 v38, 0, v58
v_max_f32 v56, v56, v38
v_mfma_f32_16x16x32_bf16 v[40:43], v[176:179], v[16:19], 0
s_cbranch_vccnz L_fb_113
s_waitcnt vmcnt(4)
L_fb_113:
s_waitcnt vmcnt(6)
buffer_load_dwordx4 v[228:231], v2, s[44:47], s9 offen nt
s_addk_i32 s9, 0x1000
v_mfma_f32_16x16x32_bf16 v[40:43], v[180:183], v[20:23], v[40:43]
s_cbranch_vccnz L_fb_114
s_waitcnt vmcnt(4)
L_fb_114:
s_waitcnt vmcnt(6)
buffer_load_dwordx4 v[232:235], v2, s[44:47], s9 offen nt
s_addk_i32 s9, 0x1000
v_mfma_f32_16x16x32_bf16 v[40:43], v[184:187], v[24:27], v[40:43]
s_cbranch_vccnz L_fb_115
s_waitcnt vmcnt(4)
L_fb_115:
s_waitcnt vmcnt(6)
buffer_load_dwordx4 v[236:239], v2, s[44:47], s9 offen nt
s_addk_i32 s9, 0x1000
v_mfma_f32_16x16x32_bf16 v[40:43], v[188:191], v[28:31], v[40:43]
s_cbranch_vccnz L_fb_116
s_waitcnt vmcnt(4)
L_fb_116:
s_waitcnt vmcnt(6)
s_mov_b32 s9, 0
buffer_load_dwordx4 v[240:243], v3, s[48:51], s9 offen nt
s_addk_i32 s9, 0x1000
v_mfma_f32_16x16x32_bf16 v[44:47], v[192:195], v[16:19], 0
s_cbranch_vccnz L_fb_117
s_waitcnt vmcnt(4)
L_fb_117:
s_waitcnt vmcnt(6)
buffer_load_dwordx4 v[244:247], v3, s[48:51], s9 offen nt
s_addk_i32 s9, 0x1000
v_mfma_f32_16x16x32_bf16 v[44:47], v[196:199], v[20:23], v[44:47]
s_cbranch_vccnz L_fb_118
s_waitcnt vmcnt(4)
L_fb_118:
s_waitcnt vmcnt(6)
buffer_load_dwordx4 v[248:251], v3, s[48:51], s9 offen nt
s_addk_i32 s9, 0x1000
v_mfma_f32_16x16x32_bf16 v[44:47], v[200:203], v[24:27], v[44:47]
s_cbranch_vccnz L_fb_119
s_waitcnt vmcnt(4)
L_fb_119:
s_waitcnt vmcnt(6)
buffer_load_dwordx4 v[252:255], v3, s[48:51], s9 offen nt
s_addk_i32 s9, 0x1000
v_mfma_f32_16x16x32_bf16 v[44:47], v[204:207], v[28:31], v[44:47]
s_cbranch_vccnz L_fb_120
s_waitcnt vmcnt(4)
L_fb_120:
s_waitcnt vmcnt(6)
buffer_load_dwordx4 v[80:83], v3, s[48:51], s9 offen nt
s_addk_i32 s9, 0x1000
v_mfma_f32_16x16x32_bf16 v[48:51], v[208:211], v[16:19], 0
s_cbranch_vccnz L_fb_121
s_waitcnt vmcnt(4)
L_fb_121:
s_waitcnt vmcnt(6)
buffer_load_dwordx4 v[84:87], v3, s[48:51], s9 offen nt
s_addk_i32 s9, 0x1000
v_mfma_f32_16x16x32_bf16 v[48:51], v[212:215], v[20:23], v[48:51]
s_cbranch_vccnz L_fb_122
s_waitcnt vmcnt(4)
L_fb_122:
s_waitcnt vmcnt(6)
buffer_load_dwordx4 v[88:91], v3, s[48:51], s9 offen nt
s_addk_i32 s9, 0x1000
v_mfma_f32_16x16x32_bf16 v[48:51], v[216:219], v[24:27], v[48:51]
s_cbranch_vccnz L_fb_123
s_waitcnt vmcnt(4)
L_fb_123:
s_waitcnt vmcnt(6)
buffer_load_dwordx4 v[92:95], v3, s[48:51], s9 offen nt
s_addk_i32 s9, 0x1000
v_mfma_f32_16x16x32_bf16 v[48:51], v[220:223], v[28:31], v[48:51]
s_memrealtime s[60:61]
s_cbranch_vccnz L_fb_124
s_waitcnt vmcnt(4)
L_fb_124:
s_waitcnt vmcnt(6)
buffer_load_dwordx4 v[96:99], v3, s[48:51], s9 offen nt
s_addk_i32 s9, 0x1000
v_mfma_f32_16x16x32_bf16 v[52:55], v[224:227], v[16:19], 0
s_cbranch_vccnz L_fb_125
s_waitcnt vmcnt(4)
L_fb_125:
s_waitcnt vmcnt(6)
buffer_load_dwordx4 v[100:103], v3, s[48:51], s9 offen nt
s_addk_i32 s9, 0x1000
v_mfma_f32_16x16x32_bf16 v[52:55], v[228:231], v[20:23], v[52:55]
s_cbranch_vccnz L_fb_126
s_waitcnt vmcnt(4)
L_fb_126:
s_waitcnt vmcnt(6)
buffer_load_dwordx4 v[104:107], v3, s[48:51], s9 offen nt
s_addk_i32 s9, 0x1000
v_mfma_f32_16x16x32_bf16 v[52:55], v[232:235], v[24:27], v[52:55]
s_cbranch_vccnz L_fb_127
s_waitcnt vmcnt(4)
L_fb_127:
s_waitcnt vmcnt(6)
buffer_load_dwordx4 v[108:111], v3, s[48:51], s9 offen nt
s_addk_i32 s9, 0x1000
v_mfma_f32_16x16x32_bf16 v[52:55], v[236:239], v[28:31], v[52:55]
s_waitcnt lgkmcnt(0)
s_sub_u32 s60, s60, s62
s_cmp_gt_u32 s60, 2105
s_cselect_b64 vcc, -1, 0
s_cbranch_vccnz L_fb_128
s_waitcnt vmcnt(4)
L_fb_128:
s_waitcnt vmcnt(6)
buffer_load_dwordx4 v[112:115], v3, s[48:51], s9 offen nt
s_addk_i32 s9, 0x1000
v_mov_b32_dpp v58, v40 quad_perm:[0,0,0,0] row_mask:0xf bank_mask:0xf
v_add_f32_dpp v58, v41, v58 quad_perm:[1,1,1,1] row_mask:0xf bank_mask:0xf
v_add_f32_dpp v58, v42, v58 quad_perm:[2,2,2,2] row_mask:0xf bank_mask:0xf
v_add_f32_dpp v58, v43, v58 quad_perm:[3,3,3,3] row_mask:0xf bank_mask:0xf
v_mov_b32_dpp v59, v44 quad_perm:[0,0,0,0] row_mask:0xf bank_mask:0xf
v_add_f32_dpp v59, v45, v59 quad_perm:[1,1,1,1] row_mask:0xf bank_mask:0xf
v_add_f32_dpp v59, v46, v59 quad_perm:[2,2,2,2] row_mask:0xf bank_mask:0xf
v_add_f32_dpp v59, v47, v59 quad_perm:[3,3,3,3] row_mask:0xf bank_mask:0xf
v_mov_b32_dpp v60, v48 quad_perm:[0,0,0,0] row_mask:0xf bank_mask:0xf
v_add_f32_dpp v60, v49, v60 quad_perm:[1,1,1,1] row_mask:0xf bank_mask:0xf
v_add_f32_dpp v60, v50, v60 quad_perm:[2,2,2,2] row_mask:0xf bank_mask:0xf
v_add_f32_dpp v60, v51, v60 quad_perm:[3,3,3,3] row_mask:0xf bank_mask:0xf
v_mov_b32_dpp v61, v52 quad_perm:[0,0,0,0] row_mask:0xf bank_mask:0xf
v_add_f32_dpp v61, v53, v61 quad_perm:[1,1,1,1] row_mask:0xf bank_mask:0xf
v_add_f32_dpp v61, v54, v61 quad_perm:[2,2,2,2] row_mask:0xf bank_mask:0xf
v_add_f32_dpp v61, v55, v61 quad_perm:[3,3,3,3] row_mask:0xf bank_mask:0xf
v_cndmask_b32 v58, v58, v59, s[96:97]
v_cndmask_b32 v58, v58, v60, s[98:99]
v_cndmask_b32 v58, v58, v61, s[100:101]
v_cvt_pk_bf16_f32 v58, 0, v58
v_mul_f32 v58, s42, v58
v_cvt_pk_bf16_f32 v39, 0, v58
v_max_f32 v56, v56, v39
s_nop 1
v_max_f32_dpp v56, v56, v56 quad_perm:[1,0,3,2] row_mask:0xf bank_mask:0xf
s_nop 1
v_max_f32_dpp v56, v56, v56 quad_perm:[2,3,0,1] row_mask:0xf bank_mask:0xf
s_nop 1
v_max_f32_dpp v56, v56, v56 row_half_mirror row_mask:0xf bank_mask:0xf
s_nop 1
v_max_f32_dpp v56, v56, v56 row_mirror row_mask:0xf bank_mask:0xf
s_nop 1
v_max_f32_dpp v56, v56, v56 row_bcast:15 row_mask:0xa bank_mask:0xf
s_nop 1
v_max_f32_dpp v56, v56, v56 row_bcast:31 row_mask:0xc bank_mask:0xf
s_nop 1
v_readlane_b32 s42, v56, 63
s_mov_b32 s43, 0x3fb8aa3b
s_cbranch_vccnz L_fb_129
s_waitcnt vmcnt(4)
L_fb_129:
s_waitcnt vmcnt(6)
buffer_load_dwordx4 v[116:119], v3, s[48:51], s9 offen nt
s_addk_i32 s9, 0x1000
v_subrev_f32 v58, s42, v32
v_subrev_f32 v59, s42, v33
v_subrev_f32 v60, s42, v34
v_subrev_f32 v61, s42, v35
v_subrev_f32 v62, s42, v36
v_subrev_f32 v63, s42, v37
v_subrev_f32 v64, s42, v38
v_subrev_f32 v65, s42, v39
v_mul_f32 v58, s43, v58
v_mul_f32 v59, s43, v59
v_mul_f32 v60, s43, v60
v_mul_f32 v61, s43, v61
v_mul_f32 v62, s43, v62
v_mul_f32 v63, s43, v63
v_mul_f32 v64, s43, v64
v_mul_f32 v65, s43, v65
v_exp_f32 v58, v58
v_exp_f32 v59, v59
v_exp_f32 v60, v60
v_exp_f32 v61, v61
v_exp_f32 v62, v62
v_exp_f32 v63, v63
v_exp_f32 v64, v64
v_exp_f32 v65, v65
s_cbranch_vccnz L_fb_130
s_waitcnt vmcnt(4)
L_fb_130:
s_waitcnt vmcnt(6)
buffer_load_dwordx4 v[120:123], v3, s[48:51], s9 offen nt
s_addk_i32 s9, 0x1000
v_cvt_pk_bf16_f32 v32, v58, v58
v_cvt_pk_bf16_f32 v33, v59, v59
v_cvt_pk_bf16_f32 v34, v60, v60
v_cvt_pk_bf16_f32 v35, v61, v61
v_cvt_pk_bf16_f32 v36, v62, v62
v_cvt_pk_bf16_f32 v37, v63, v63
v_cvt_pk_bf16_f32 v38, v64, v64
v_cvt_pk_bf16_f32 v39, v65, v65
v_add_f32 v58, v58, v62
v_add_f32 v59, v59, v63
v_add_f32 v60, v60, v64
v_add_f32 v61, v61, v65
v_add_f32 v58, v58, v59
v_add_f32 v60, v60, v61
v_add_f32 v67, v58, v60
v_and_b32_dpp v8, v32, v4 row_newbcast:0 row_mask:0xf bank_mask:0xf
v_and_b32_dpp v9, v32, v5 row_newbcast:0 row_mask:0xf bank_mask:0xf
v_and_b32_dpp v10, v32, v6 row_newbcast:0 row_mask:0xf bank_mask:0xf
v_and_b32_dpp v11, v32, v7 row_newbcast:0 row_mask:0xf bank_mask:0xf
v_add_f32_dpp v67, v67, v67 quad_perm:[1,0,3,2] row_mask:0xf bank_mask:0xf
s_nop 1
v_add_f32_dpp v67, v67, v67 quad_perm:[2,3,0,1] row_mask:0xf bank_mask:0xf
s_nop 1
v_add_f32_dpp v67, v67, v67 row_half_mirror row_mask:0xf bank_mask:0xf
s_nop 1
v_add_f32_dpp v67, v67, v67 row_mirror row_mask:0xf bank_mask:0xf
s_nop 1
v_add_f32_dpp v67, v67, v67 row_bcast:15 row_mask:0xa bank_mask:0xf
s_nop 1
v_add_f32_dpp v67, v67, v67 row_bcast:31 row_mask:0xc bank_mask:0xf
s_nop 1
v_mov_b32 v66, s42
v_min_u32 v67, -2, v67
s_lshl_b32 s11, s4, 3
v_mov_b32 v68, s11
s_lshl_b64 exec, 1, 63
ds_write_b64 v68, v[66:67] offset:256
s_mov_b64 exec, -1
v_mfma_f32_16x16x32_bf16 v[40:43], v[8:11], v[240:243], 0
v_and_b32_dpp v12, v32, v4 row_newbcast:4 row_mask:0xf bank_mask:0xf
v_and_b32_dpp v13, v32, v5 row_newbcast:4 row_mask:0xf bank_mask:0xf
v_and_b32_dpp v14, v32, v6 row_newbcast:4 row_mask:0xf bank_mask:0xf
v_and_b32_dpp v15, v32, v7 row_newbcast:4 row_mask:0xf bank_mask:0xf
s_nop 1
v_mfma_f32_16x16x32_bf16 v[40:43], v[12:15], v[244:247], v[40:43]
v_and_b32_dpp v8, v32, v4 row_newbcast:8 row_mask:0xf bank_mask:0xf
v_and_b32_dpp v9, v32, v5 row_newbcast:8 row_mask:0xf bank_mask:0xf
v_and_b32_dpp v10, v32, v6 row_newbcast:8 row_mask:0xf bank_mask:0xf
v_and_b32_dpp v11, v32, v7 row_newbcast:8 row_mask:0xf bank_mask:0xf
s_cbranch_vccnz L_fb_131
s_waitcnt vmcnt(4)
L_fb_131:
s_waitcnt vmcnt(6)
buffer_load_dwordx4 v[124:127], v3, s[48:51], s9 offen nt
s_addk_i32 s9, 0x1000
v_mfma_f32_16x16x32_bf16 v[40:43], v[8:11], v[248:251], v[40:43]
v_and_b32_dpp v12, v32, v4 row_newbcast:12 row_mask:0xf bank_mask:0xf
v_and_b32_dpp v13, v32, v5 row_newbcast:12 row_mask:0xf bank_mask:0xf
v_and_b32_dpp v14, v32, v6 row_newbcast:12 row_mask:0xf bank_mask:0xf
v_and_b32_dpp v15, v32, v7 row_newbcast:12 row_mask:0xf bank_mask:0xf
s_nop 1
v_mfma_f32_16x16x32_bf16 v[40:43], v[12:15], v[252:255], v[40:43]
v_and_b32_dpp v8, v32, v4 row_newbcast:1 row_mask:0xf bank_mask:0xf
v_and_b32_dpp v9, v32, v5 row_newbcast:1 row_mask:0xf bank_mask:0xf
v_and_b32_dpp v10, v32, v6 row_newbcast:1 row_mask:0xf bank_mask:0xf
v_and_b32_dpp v11, v32, v7 row_newbcast:1 row_mask:0xf bank_mask:0xf
s_cbranch_vccnz L_fb_132
s_waitcnt vmcnt(4)
L_fb_132:
s_waitcnt vmcnt(6)
buffer_load_dwordx4 v[128:131], v3, s[48:51], s9 offen nt
s_addk_i32 s9, 0x1000
v_mfma_f32_16x16x32_bf16 v[40:43], v[8:11], v[80:83], v[40:43]
v_and_b32_dpp v12, v32, v4 row_newbcast:5 row_mask:0xf bank_mask:0xf
v_and_b32_dpp v13, v32, v5 row_newbcast:5 row_mask:0xf bank_mask:0xf
v_and_b32_dpp v14, v32, v6 row_newbcast:5 row_mask:0xf bank_mask:0xf
v_and_b32_dpp v15, v32, v7 row_newbcast:5 row_mask:0xf bank_mask:0xf
s_cbranch_vccnz L_fb_133
s_waitcnt vmcnt(4)
L_fb_133:
s_waitcnt vmcnt(6)
buffer_load_dwordx4 v[132:135], v3, s[48:51], s9 offen nt
s_addk_i32 s9, 0x1000
v_mfma_f32_16x16x32_bf16 v[40:43], v[12:15], v[84:87], v[40:43]
v_and_b32_dpp v8, v32, v4 row_newbcast:9 row_mask:0xf bank_mask:0xf
v_and_b32_dpp v9, v32, v5 row_newbcast:9 row_mask:0xf bank_mask:0xf
v_and_b32_dpp v10, v32, v6 row_newbcast:9 row_mask:0xf bank_mask:0xf
v_and_b32_dpp v11, v32, v7 row_newbcast:9 row_mask:0xf bank_mask:0xf
s_cbranch_vccnz L_fb_134
s_waitcnt vmcnt(4)
L_fb_134:
s_waitcnt vmcnt(6)
buffer_load_dwordx4 v[136:139], v3, s[48:51], s9 offen nt
s_addk_i32 s9, 0x1000
v_mfma_f32_16x16x32_bf16 v[40:43], v[8:11], v[88:91], v[40:43]
v_and_b32_dpp v12, v32, v4 row_newbcast:13 row_mask:0xf bank_mask:0xf
v_and_b32_dpp v13, v32, v5 row_newbcast:13 row_mask:0xf bank_mask:0xf
v_and_b32_dpp v14, v32, v6 row_newbcast:13 row_mask:0xf bank_mask:0xf
v_and_b32_dpp v15, v32, v7 row_newbcast:13 row_mask:0xf bank_mask:0xf
s_cbranch_vccnz L_fb_135
s_waitcnt vmcnt(4)
L_fb_135:
s_waitcnt vmcnt(6)
buffer_load_dwordx4 v[140:143], v3, s[48:51], s9 offen nt
s_addk_i32 s9, 0x1000
v_mfma_f32_16x16x32_bf16 v[40:43], v[12:15], v[92:95], v[40:43]
v_and_b32_dpp v8, v32, v4 row_newbcast:2 row_mask:0xf bank_mask:0xf
v_and_b32_dpp v9, v32, v5 row_newbcast:2 row_mask:0xf bank_mask:0xf
v_and_b32_dpp v10, v32, v6 row_newbcast:2 row_mask:0xf bank_mask:0xf
v_and_b32_dpp v11, v32, v7 row_newbcast:2 row_mask:0xf bank_mask:0xf
s_cbranch_vccnz L_fb_136
s_waitcnt vmcnt(4)
L_fb_136:
s_waitcnt vmcnt(6)
buffer_load_dwordx4 v[144:147], v3, s[48:51], s9 offen nt
s_addk_i32 s9, 0x1000
v_mfma_f32_16x16x32_bf16 v[40:43], v[8:11], v[96:99], v[40:43]
v_and_b32_dpp v12, v32, v4 row_newbcast:6 row_mask:0xf bank_mask:0xf
v_and_b32_dpp v13, v32, v5 row_newbcast:6 row_mask:0xf bank_mask:0xf
v_and_b32_dpp v14, v32, v6 row_newbcast:6 row_mask:0xf bank_mask:0xf
v_and_b32_dpp v15, v32, v7 row_newbcast:6 row_mask:0xf bank_mask:0xf
s_cbranch_vccnz L_fb_137
s_waitcnt vmcnt(4)
L_fb_137:
s_waitcnt vmcnt(6)
buffer_load_dwordx4 v[148:151], v3, s[48:51], s9 offen nt
s_addk_i32 s9, 0x1000
v_mfma_f32_16x16x32_bf16 v[40:43], v[12:15], v[100:103], v[40:43]
v_and_b32_dpp v8, v32, v4 row_newbcast:10 row_mask:0xf bank_mask:0xf
v_and_b32_dpp v9, v32, v5 row_newbcast:10 row_mask:0xf bank_mask:0xf
v_and_b32_dpp v10, v32, v6 row_newbcast:10 row_mask:0xf bank_mask:0xf
v_and_b32_dpp v11, v32, v7 row_newbcast:10 row_mask:0xf bank_mask:0xf
s_cbranch_vccnz L_fb_138
s_waitcnt vmcnt(4)
L_fb_138:
s_waitcnt vmcnt(6)
buffer_load_dwordx4 v[152:155], v3, s[48:51], s9 offen nt
s_addk_i32 s9, 0x1000
v_mfma_f32_16x16x32_bf16 v[40:43], v[8:11], v[104:107], v[40:43]
v_and_b32_dpp v12, v32, v4 row_newbcast:14 row_mask:0xf bank_mask:0xf
v_and_b32_dpp v13, v32, v5 row_newbcast:14 row_mask:0xf bank_mask:0xf
v_and_b32_dpp v14, v32, v6 row_newbcast:14 row_mask:0xf bank_mask:0xf
v_and_b32_dpp v15, v32, v7 row_newbcast:14 row_mask:0xf bank_mask:0xf
s_cbranch_vccnz L_fb_139
s_waitcnt vmcnt(4)
L_fb_139:
s_waitcnt vmcnt(6)
buffer_load_dwordx4 v[156:159], v3, s[48:51], s9 offen nt
s_addk_i32 s9, 0x1000
v_mfma_f32_16x16x32_bf16 v[40:43], v[12:15], v[108:111], v[40:43]
v_and_b32_dpp v8, v32, v4 row_newbcast:3 row_mask:0xf bank_mask:0xf
v_and_b32_dpp v9, v32, v5 row_newbcast:3 row_mask:0xf bank_mask:0xf
v_and_b32_dpp v10, v32, v6 row_newbcast:3 row_mask:0xf bank_mask:0xf
v_and_b32_dpp v11, v32, v7 row_newbcast:3 row_mask:0xf bank_mask:0xf
s_memrealtime s[60:61]
s_cbranch_vccnz L_fb_140
s_waitcnt vmcnt(4)
L_fb_140:
s_waitcnt vmcnt(6)
buffer_load_dwordx4 v[160:163], v3, s[48:51], s9 offen nt
s_addk_i32 s9, 0x1000
v_mfma_f32_16x16x32_bf16 v[40:43], v[8:11], v[112:115], v[40:43]
v_and_b32_dpp v12, v32, v4 row_newbcast:7 row_mask:0xf bank_mask:0xf
v_and_b32_dpp v13, v32, v5 row_newbcast:7 row_mask:0xf bank_mask:0xf
v_and_b32_dpp v14, v32, v6 row_newbcast:7 row_mask:0xf bank_mask:0xf
v_and_b32_dpp v15, v32, v7 row_newbcast:7 row_mask:0xf bank_mask:0xf
s_cbranch_vccnz L_fb_141
s_waitcnt vmcnt(4)
L_fb_141:
s_waitcnt vmcnt(6)
buffer_load_dwordx4 v[164:167], v3, s[48:51], s9 offen nt
s_addk_i32 s9, 0x1000
v_mfma_f32_16x16x32_bf16 v[40:43], v[12:15], v[116:119], v[40:43]
v_and_b32_dpp v8, v32, v4 row_newbcast:11 row_mask:0xf bank_mask:0xf
v_and_b32_dpp v9, v32, v5 row_newbcast:11 row_mask:0xf bank_mask:0xf
v_and_b32_dpp v10, v32, v6 row_newbcast:11 row_mask:0xf bank_mask:0xf
v_and_b32_dpp v11, v32, v7 row_newbcast:11 row_mask:0xf bank_mask:0xf
s_cbranch_vccnz L_fb_142
s_waitcnt vmcnt(4)
L_fb_142:
s_waitcnt vmcnt(6)
buffer_load_dwordx4 v[168:171], v3, s[48:51], s9 offen nt
s_addk_i32 s9, 0x1000
v_mfma_f32_16x16x32_bf16 v[40:43], v[8:11], v[120:123], v[40:43]
v_and_b32_dpp v12, v32, v4 row_newbcast:15 row_mask:0xf bank_mask:0xf
v_and_b32_dpp v13, v32, v5 row_newbcast:15 row_mask:0xf bank_mask:0xf
v_and_b32_dpp v14, v32, v6 row_newbcast:15 row_mask:0xf bank_mask:0xf
v_and_b32_dpp v15, v32, v7 row_newbcast:15 row_mask:0xf bank_mask:0xf
s_cbranch_vccnz L_fb_143
s_waitcnt vmcnt(4)
L_fb_143:
s_waitcnt vmcnt(6)
buffer_load_dwordx4 v[172:175], v3, s[48:51], s9 offen nt
s_addk_i32 s9, 0x1000
v_mfma_f32_16x16x32_bf16 v[40:43], v[12:15], v[124:127], v[40:43]
v_and_b32_dpp v8, v33, v4 row_newbcast:0 row_mask:0xf bank_mask:0xf
v_and_b32_dpp v9, v33, v5 row_newbcast:0 row_mask:0xf bank_mask:0xf
v_and_b32_dpp v10, v33, v6 row_newbcast:0 row_mask:0xf bank_mask:0xf
v_and_b32_dpp v11, v33, v7 row_newbcast:0 row_mask:0xf bank_mask:0xf
s_waitcnt lgkmcnt(0)
s_sub_u32 s60, s60, s62
s_cmp_gt_u32 s60, 2350
s_cselect_b64 vcc, -1, 0
s_cbranch_vccnz L_fb_144
s_waitcnt vmcnt(4)
L_fb_144:
s_waitcnt vmcnt(6)
buffer_load_dwordx4 v[176:179], v3, s[48:51], s9 offen nt
s_addk_i32 s9, 0x1000
v_mfma_f32_16x16x32_bf16 v[40:43], v[8:11], v[128:131], v[40:43]
v_and_b32_dpp v12, v33, v4 row_newbcast:4 row_mask:0xf bank_mask:0xf
v_and_b32_dpp v13, v33, v5 row_newbcast:4 row_mask:0xf bank_mask:0xf
v_and_b32_dpp v14, v33, v6 row_newbcast:4 row_mask:0xf bank_mask:0xf
v_and_b32_dpp v15, v33, v7 row_newbcast:4 row_mask:0xf bank_mask:0xf
s_cbranch_vccnz L_fb_145
s_waitcnt vmcnt(4)
L_fb_145:
s_waitcnt vmcnt(6)
buffer_load_dwordx4 v[180:183], v3, s[48:51], s9 offen nt
s_addk_i32 s9, 0x1000
v_mfma_f32_16x16x32_bf16 v[40:43], v[12:15], v[132:135], v[40:43]
v_and_b32_dpp v8, v33, v4 row_newbcast:8 row_mask:0xf bank_mask:0xf
v_and_b32_dpp v9, v33, v5 row_newbcast:8 row_mask:0xf bank_mask:0xf
v_and_b32_dpp v10, v33, v6 row_newbcast:8 row_mask:0xf bank_mask:0xf
v_and_b32_dpp v11, v33, v7 row_newbcast:8 row_mask:0xf bank_mask:0xf
s_cbranch_vccnz L_fb_146
s_waitcnt vmcnt(4)
L_fb_146:
s_waitcnt vmcnt(6)
buffer_load_dwordx4 v[184:187], v3, s[48:51], s9 offen nt
s_addk_i32 s9, 0x1000
v_mfma_f32_16x16x32_bf16 v[40:43], v[8:11], v[136:139], v[40:43]
v_and_b32_dpp v12, v33, v4 row_newbcast:12 row_mask:0xf bank_mask:0xf
v_and_b32_dpp v13, v33, v5 row_newbcast:12 row_mask:0xf bank_mask:0xf
v_and_b32_dpp v14, v33, v6 row_newbcast:12 row_mask:0xf bank_mask:0xf
v_and_b32_dpp v15, v33, v7 row_newbcast:12 row_mask:0xf bank_mask:0xf
s_cbranch_vccnz L_fb_147
s_waitcnt vmcnt(4)
L_fb_147:
s_waitcnt vmcnt(6)
buffer_load_dwordx4 v[188:191], v3, s[48:51], s9 offen nt
s_addk_i32 s9, 0x1000
v_mfma_f32_16x16x32_bf16 v[40:43], v[12:15], v[140:143], v[40:43]
v_and_b32_dpp v8, v33, v4 row_newbcast:1 row_mask:0xf bank_mask:0xf
v_and_b32_dpp v9, v33, v5 row_newbcast:1 row_mask:0xf bank_mask:0xf
v_and_b32_dpp v10, v33, v6 row_newbcast:1 row_mask:0xf bank_mask:0xf
v_and_b32_dpp v11, v33, v7 row_newbcast:1 row_mask:0xf bank_mask:0xf
s_cbranch_vccnz L_fb_148
s_waitcnt vmcnt(4)
L_fb_148:
s_waitcnt vmcnt(6)
buffer_load_dwordx4 v[192:195], v3, s[48:51], s9 offen nt
s_addk_i32 s9, 0x1000
v_mfma_f32_16x16x32_bf16 v[40:43], v[8:11], v[144:147], v[40:43]
v_and_b32_dpp v12, v33, v4 row_newbcast:5 row_mask:0xf bank_mask:0xf
v_and_b32_dpp v13, v33, v5 row_newbcast:5 row_mask:0xf bank_mask:0xf
v_and_b32_dpp v14, v33, v6 row_newbcast:5 row_mask:0xf bank_mask:0xf
v_and_b32_dpp v15, v33, v7 row_newbcast:5 row_mask:0xf bank_mask:0xf
s_cbranch_vccnz L_fb_149
s_waitcnt vmcnt(4)
L_fb_149:
s_waitcnt vmcnt(6)
buffer_load_dwordx4 v[196:199], v3, s[48:51], s9 offen nt
s_addk_i32 s9, 0x1000
v_mfma_f32_16x16x32_bf16 v[40:43], v[12:15], v[148:151], v[40:43]
v_and_b32_dpp v8, v33, v4 row_newbcast:9 row_mask:0xf bank_mask:0xf
v_and_b32_dpp v9, v33, v5 row_newbcast:9 row_mask:0xf bank_mask:0xf
v_and_b32_dpp v10, v33, v6 row_newbcast:9 row_mask:0xf bank_mask:0xf
v_and_b32_dpp v11, v33, v7 row_newbcast:9 row_mask:0xf bank_mask:0xf
s_cbranch_vccnz L_fb_150
s_waitcnt vmcnt(4)
L_fb_150:
s_waitcnt vmcnt(6)
buffer_load_dwordx4 v[200:203], v3, s[48:51], s9 offen nt
s_addk_i32 s9, 0x1000
v_mfma_f32_16x16x32_bf16 v[40:43], v[8:11], v[152:155], v[40:43]
v_and_b32_dpp v12, v33, v4 row_newbcast:13 row_mask:0xf bank_mask:0xf
v_and_b32_dpp v13, v33, v5 row_newbcast:13 row_mask:0xf bank_mask:0xf
v_and_b32_dpp v14, v33, v6 row_newbcast:13 row_mask:0xf bank_mask:0xf
v_and_b32_dpp v15, v33, v7 row_newbcast:13 row_mask:0xf bank_mask:0xf
s_cbranch_vccnz L_fb_151
s_waitcnt vmcnt(4)
L_fb_151:
s_waitcnt vmcnt(6)
buffer_load_dwordx4 v[204:207], v3, s[48:51], s9 offen nt
s_addk_i32 s9, 0x1000
v_mfma_f32_16x16x32_bf16 v[40:43], v[12:15], v[156:159], v[40:43]
v_and_b32_dpp v8, v33, v4 row_newbcast:2 row_mask:0xf bank_mask:0xf
v_and_b32_dpp v9, v33, v5 row_newbcast:2 row_mask:0xf bank_mask:0xf
v_and_b32_dpp v10, v33, v6 row_newbcast:2 row_mask:0xf bank_mask:0xf
v_and_b32_dpp v11, v33, v7 row_newbcast:2 row_mask:0xf bank_mask:0xf
s_cbranch_vccnz L_fb_152
s_waitcnt vmcnt(4)
L_fb_152:
s_waitcnt vmcnt(6)
buffer_load_dwordx4 v[208:211], v3, s[48:51], s9 offen nt
s_addk_i32 s9, 0x1000
v_mfma_f32_16x16x32_bf16 v[40:43], v[8:11], v[160:163], v[40:43]
v_and_b32_dpp v12, v33, v4 row_newbcast:6 row_mask:0xf bank_mask:0xf
v_and_b32_dpp v13, v33, v5 row_newbcast:6 row_mask:0xf bank_mask:0xf
v_and_b32_dpp v14, v33, v6 row_newbcast:6 row_mask:0xf bank_mask:0xf
v_and_b32_dpp v15, v33, v7 row_newbcast:6 row_mask:0xf bank_mask:0xf
s_cbranch_vccnz L_fb_153
s_waitcnt vmcnt(4)
L_fb_153:
s_waitcnt vmcnt(6)
buffer_load_dwordx4 v[212:215], v3, s[48:51], s9 offen nt
s_addk_i32 s9, 0x1000
v_mfma_f32_16x16x32_bf16 v[40:43], v[12:15], v[164:167], v[40:43]
v_and_b32_dpp v8, v33, v4 row_newbcast:10 row_mask:0xf bank_mask:0xf
v_and_b32_dpp v9, v33, v5 row_newbcast:10 row_mask:0xf bank_mask:0xf
v_and_b32_dpp v10, v33, v6 row_newbcast:10 row_mask:0xf bank_mask:0xf
v_and_b32_dpp v11, v33, v7 row_newbcast:10 row_mask:0xf bank_mask:0xf
s_cbranch_vccnz L_fb_154
s_waitcnt vmcnt(4)
L_fb_154:
s_waitcnt vmcnt(6)
buffer_load_dwordx4 v[216:219], v3, s[48:51], s9 offen nt
s_addk_i32 s9, 0x1000
v_mfma_f32_16x16x32_bf16 v[40:43], v[8:11], v[168:171], v[40:43]
v_and_b32_dpp v12, v33, v4 row_newbcast:14 row_mask:0xf bank_mask:0xf
v_and_b32_dpp v13, v33, v5 row_newbcast:14 row_mask:0xf bank_mask:0xf
v_and_b32_dpp v14, v33, v6 row_newbcast:14 row_mask:0xf bank_mask:0xf
v_and_b32_dpp v15, v33, v7 row_newbcast:14 row_mask:0xf bank_mask:0xf
s_cbranch_vccnz L_fb_155
s_waitcnt vmcnt(4)
L_fb_155:
s_waitcnt vmcnt(6)
buffer_load_dwordx4 v[220:223], v3, s[48:51], s9 offen nt
s_addk_i32 s9, 0x1000
v_mfma_f32_16x16x32_bf16 v[40:43], v[12:15], v[172:175], v[40:43]
v_and_b32_dpp v8, v33, v4 row_newbcast:3 row_mask:0xf bank_mask:0xf
v_and_b32_dpp v9, v33, v5 row_newbcast:3 row_mask:0xf bank_mask:0xf
v_and_b32_dpp v10, v33, v6 row_newbcast:3 row_mask:0xf bank_mask:0xf
v_and_b32_dpp v11, v33, v7 row_newbcast:3 row_mask:0xf bank_mask:0xf
s_memrealtime s[60:61]
s_cbranch_vccnz L_fb_156
s_waitcnt vmcnt(4)
L_fb_156:
s_waitcnt vmcnt(6)
buffer_load_dwordx4 v[224:227], v3, s[48:51], s9 offen nt
s_addk_i32 s9, 0x1000
v_mfma_f32_16x16x32_bf16 v[40:43], v[8:11], v[176:179], v[40:43]
v_and_b32_dpp v12, v33, v4 row_newbcast:7 row_mask:0xf bank_mask:0xf
v_and_b32_dpp v13, v33, v5 row_newbcast:7 row_mask:0xf bank_mask:0xf
v_and_b32_dpp v14, v33, v6 row_newbcast:7 row_mask:0xf bank_mask:0xf
v_and_b32_dpp v15, v33, v7 row_newbcast:7 row_mask:0xf bank_mask:0xf
s_cbranch_vccnz L_fb_157
s_waitcnt vmcnt(4)
L_fb_157:
s_waitcnt vmcnt(6)
buffer_load_dwordx4 v[228:231], v3, s[48:51], s9 offen nt
s_addk_i32 s9, 0x1000
v_mfma_f32_16x16x32_bf16 v[40:43], v[12:15], v[180:183], v[40:43]
v_and_b32_dpp v8, v33, v4 row_newbcast:11 row_mask:0xf bank_mask:0xf
v_and_b32_dpp v9, v33, v5 row_newbcast:11 row_mask:0xf bank_mask:0xf
v_and_b32_dpp v10, v33, v6 row_newbcast:11 row_mask:0xf bank_mask:0xf
v_and_b32_dpp v11, v33, v7 row_newbcast:11 row_mask:0xf bank_mask:0xf
s_cbranch_vccnz L_fb_158
s_waitcnt vmcnt(4)
L_fb_158:
s_waitcnt vmcnt(6)
buffer_load_dwordx4 v[232:235], v3, s[48:51], s9 offen nt
s_addk_i32 s9, 0x1000
v_mfma_f32_16x16x32_bf16 v[40:43], v[8:11], v[184:187], v[40:43]
v_and_b32_dpp v12, v33, v4 row_newbcast:15 row_mask:0xf bank_mask:0xf
v_and_b32_dpp v13, v33, v5 row_newbcast:15 row_mask:0xf bank_mask:0xf
v_and_b32_dpp v14, v33, v6 row_newbcast:15 row_mask:0xf bank_mask:0xf
v_and_b32_dpp v15, v33, v7 row_newbcast:15 row_mask:0xf bank_mask:0xf
s_cbranch_vccnz L_fb_159
s_waitcnt vmcnt(4)
L_fb_159:
s_waitcnt vmcnt(6)
buffer_load_dwordx4 v[236:239], v3, s[48:51], s9 offen nt
s_addk_i32 s9, 0x1000
v_mfma_f32_16x16x32_bf16 v[40:43], v[12:15], v[188:191], v[40:43]
v_and_b32_dpp v8, v34, v4 row_newbcast:0 row_mask:0xf bank_mask:0xf
v_and_b32_dpp v9, v34, v5 row_newbcast:0 row_mask:0xf bank_mask:0xf
v_and_b32_dpp v10, v34, v6 row_newbcast:0 row_mask:0xf bank_mask:0xf
v_and_b32_dpp v11, v34, v7 row_newbcast:0 row_mask:0xf bank_mask:0xf
s_waitcnt lgkmcnt(0)
s_sub_u32 s60, s60, s62
s_cmp_gt_u32 s60, 2580
s_cselect_b64 vcc, -1, 0
s_cbranch_vccnz L_fb_160
s_waitcnt vmcnt(4)
L_fb_160:
s_waitcnt vmcnt(6)
buffer_load_dwordx4 v[240:243], v3, s[48:51], s9 offen nt
s_addk_i32 s9, 0x1000
v_mfma_f32_16x16x32_bf16 v[40:43], v[8:11], v[192:195], v[40:43]
v_and_b32_dpp v12, v34, v4 row_newbcast:4 row_mask:0xf bank_mask:0xf
v_and_b32_dpp v13, v34, v5 row_newbcast:4 row_mask:0xf bank_mask:0xf
v_and_b32_dpp v14, v34, v6 row_newbcast:4 row_mask:0xf bank_mask:0xf
v_and_b32_dpp v15, v34, v7 row_newbcast:4 row_mask:0xf bank_mask:0xf
s_cbranch_vccnz L_fb_161
s_waitcnt vmcnt(4)
L_fb_161:
s_waitcnt vmcnt(6)
buffer_load_dwordx4 v[244:247], v3, s[48:51], s9 offen nt
s_addk_i32 s9, 0x1000
v_mfma_f32_16x16x32_bf16 v[40:43], v[12:15], v[196:199], v[40:43]
v_and_b32_dpp v8, v34, v4 row_newbcast:8 row_mask:0xf bank_mask:0xf
v_and_b32_dpp v9, v34, v5 row_newbcast:8 row_mask:0xf bank_mask:0xf
v_and_b32_dpp v10, v34, v6 row_newbcast:8 row_mask:0xf bank_mask:0xf
v_and_b32_dpp v11, v34, v7 row_newbcast:8 row_mask:0xf bank_mask:0xf
s_cbranch_vccnz L_fb_162
s_waitcnt vmcnt(4)
L_fb_162:
s_waitcnt vmcnt(6)
buffer_load_dwordx4 v[248:251], v3, s[48:51], s9 offen nt
s_addk_i32 s9, 0x1000
v_mfma_f32_16x16x32_bf16 v[40:43], v[8:11], v[200:203], v[40:43]
v_and_b32_dpp v12, v34, v4 row_newbcast:12 row_mask:0xf bank_mask:0xf
v_and_b32_dpp v13, v34, v5 row_newbcast:12 row_mask:0xf bank_mask:0xf
v_and_b32_dpp v14, v34, v6 row_newbcast:12 row_mask:0xf bank_mask:0xf
v_and_b32_dpp v15, v34, v7 row_newbcast:12 row_mask:0xf bank_mask:0xf
s_cbranch_vccnz L_fb_163
s_waitcnt vmcnt(4)
L_fb_163:
s_waitcnt vmcnt(6)
buffer_load_dwordx4 v[252:255], v3, s[48:51], s9 offen nt
s_addk_i32 s9, 0x1000
v_mfma_f32_16x16x32_bf16 v[40:43], v[12:15], v[204:207], v[40:43]
v_and_b32_dpp v8, v34, v4 row_newbcast:1 row_mask:0xf bank_mask:0xf
v_and_b32_dpp v9, v34, v5 row_newbcast:1 row_mask:0xf bank_mask:0xf
v_and_b32_dpp v10, v34, v6 row_newbcast:1 row_mask:0xf bank_mask:0xf
v_and_b32_dpp v11, v34, v7 row_newbcast:1 row_mask:0xf bank_mask:0xf
s_cbranch_vccnz L_fb_164
s_waitcnt vmcnt(4)
L_fb_164:
s_waitcnt vmcnt(6)
buffer_load_dwordx4 v[80:83], v3, s[48:51], s9 offen nt
s_addk_i32 s9, 0x1000
v_mfma_f32_16x16x32_bf16 v[40:43], v[8:11], v[208:211], v[40:43]
v_and_b32_dpp v12, v34, v4 row_newbcast:5 row_mask:0xf bank_mask:0xf
v_and_b32_dpp v13, v34, v5 row_newbcast:5 row_mask:0xf bank_mask:0xf
v_and_b32_dpp v14, v34, v6 row_newbcast:5 row_mask:0xf bank_mask:0xf
v_and_b32_dpp v15, v34, v7 row_newbcast:5 row_mask:0xf bank_mask:0xf
s_cbranch_vccnz L_fb_165
s_waitcnt vmcnt(4)
L_fb_165:
s_waitcnt vmcnt(6)
buffer_load_dwordx4 v[84:87], v3, s[48:51], s9 offen nt
s_addk_i32 s9, 0x1000
v_mfma_f32_16x16x32_bf16 v[40:43], v[12:15], v[212:215], v[40:43]
v_and_b32_dpp v8, v34, v4 row_newbcast:9 row_mask:0xf bank_mask:0xf
v_and_b32_dpp v9, v34, v5 row_newbcast:9 row_mask:0xf bank_mask:0xf
v_and_b32_dpp v10, v34, v6 row_newbcast:9 row_mask:0xf bank_mask:0xf
v_and_b32_dpp v11, v34, v7 row_newbcast:9 row_mask:0xf bank_mask:0xf
s_cbranch_vccnz L_fb_166
s_waitcnt vmcnt(4)
L_fb_166:
s_waitcnt vmcnt(6)
buffer_load_dwordx4 v[88:91], v3, s[48:51], s9 offen nt
s_addk_i32 s9, 0x1000
v_mfma_f32_16x16x32_bf16 v[40:43], v[8:11], v[216:219], v[40:43]
v_and_b32_dpp v12, v34, v4 row_newbcast:13 row_mask:0xf bank_mask:0xf
v_and_b32_dpp v13, v34, v5 row_newbcast:13 row_mask:0xf bank_mask:0xf
v_and_b32_dpp v14, v34, v6 row_newbcast:13 row_mask:0xf bank_mask:0xf
v_and_b32_dpp v15, v34, v7 row_newbcast:13 row_mask:0xf bank_mask:0xf
s_cbranch_vccnz L_fb_167
s_waitcnt vmcnt(4)
L_fb_167:
s_waitcnt vmcnt(6)
buffer_load_dwordx4 v[92:95], v3, s[48:51], s9 offen nt
s_addk_i32 s9, 0x1000
v_mfma_f32_16x16x32_bf16 v[40:43], v[12:15], v[220:223], v[40:43]
v_and_b32_dpp v8, v34, v4 row_newbcast:2 row_mask:0xf bank_mask:0xf
v_and_b32_dpp v9, v34, v5 row_newbcast:2 row_mask:0xf bank_mask:0xf
v_and_b32_dpp v10, v34, v6 row_newbcast:2 row_mask:0xf bank_mask:0xf
v_and_b32_dpp v11, v34, v7 row_newbcast:2 row_mask:0xf bank_mask:0xf
s_cbranch_vccnz L_fb_168
s_waitcnt vmcnt(4)
L_fb_168:
s_waitcnt vmcnt(6)
buffer_load_dwordx4 v[96:99], v3, s[48:51], s9 offen nt
s_addk_i32 s9, 0x1000
v_mfma_f32_16x16x32_bf16 v[40:43], v[8:11], v[224:227], v[40:43]
v_and_b32_dpp v12, v34, v4 row_newbcast:6 row_mask:0xf bank_mask:0xf
v_and_b32_dpp v13, v34, v5 row_newbcast:6 row_mask:0xf bank_mask:0xf
v_and_b32_dpp v14, v34, v6 row_newbcast:6 row_mask:0xf bank_mask:0xf
v_and_b32_dpp v15, v34, v7 row_newbcast:6 row_mask:0xf bank_mask:0xf
s_cbranch_vccnz L_fb_169
s_waitcnt vmcnt(4)
L_fb_169:
s_waitcnt vmcnt(6)
buffer_load_dwordx4 v[100:103], v3, s[48:51], s9 offen nt
s_addk_i32 s9, 0x1000
v_mfma_f32_16x16x32_bf16 v[40:43], v[12:15], v[228:231], v[40:43]
v_and_b32_dpp v8, v34, v4 row_newbcast:10 row_mask:0xf bank_mask:0xf
v_and_b32_dpp v9, v34, v5 row_newbcast:10 row_mask:0xf bank_mask:0xf
v_and_b32_dpp v10, v34, v6 row_newbcast:10 row_mask:0xf bank_mask:0xf
v_and_b32_dpp v11, v34, v7 row_newbcast:10 row_mask:0xf bank_mask:0xf
s_cbranch_vccnz L_fb_170
s_waitcnt vmcnt(4)
L_fb_170:
s_waitcnt vmcnt(6)
buffer_load_dwordx4 v[104:107], v3, s[48:51], s9 offen nt
s_addk_i32 s9, 0x1000
v_mfma_f32_16x16x32_bf16 v[40:43], v[8:11], v[232:235], v[40:43]
v_and_b32_dpp v12, v34, v4 row_newbcast:14 row_mask:0xf bank_mask:0xf
v_and_b32_dpp v13, v34, v5 row_newbcast:14 row_mask:0xf bank_mask:0xf
v_and_b32_dpp v14, v34, v6 row_newbcast:14 row_mask:0xf bank_mask:0xf
v_and_b32_dpp v15, v34, v7 row_newbcast:14 row_mask:0xf bank_mask:0xf
s_cbranch_vccnz L_fb_171
s_waitcnt vmcnt(4)
L_fb_171:
s_waitcnt vmcnt(6)
buffer_load_dwordx4 v[108:111], v3, s[48:51], s9 offen nt
s_addk_i32 s9, 0x1000
v_mfma_f32_16x16x32_bf16 v[40:43], v[12:15], v[236:239], v[40:43]
v_and_b32_dpp v8, v34, v4 row_newbcast:3 row_mask:0xf bank_mask:0xf
v_and_b32_dpp v9, v34, v5 row_newbcast:3 row_mask:0xf bank_mask:0xf
v_and_b32_dpp v10, v34, v6 row_newbcast:3 row_mask:0xf bank_mask:0xf
v_and_b32_dpp v11, v34, v7 row_newbcast:3 row_mask:0xf bank_mask:0xf
s_memrealtime s[60:61]
s_cbranch_vccnz L_fb_172
s_waitcnt vmcnt(4)
L_fb_172:
s_waitcnt vmcnt(6)
buffer_load_dwordx4 v[112:115], v3, s[48:51], s9 offen nt
s_addk_i32 s9, 0x1000
v_mfma_f32_16x16x32_bf16 v[40:43], v[8:11], v[240:243], v[40:43]
v_and_b32_dpp v12, v34, v4 row_newbcast:7 row_mask:0xf bank_mask:0xf
v_and_b32_dpp v13, v34, v5 row_newbcast:7 row_mask:0xf bank_mask:0xf
v_and_b32_dpp v14, v34, v6 row_newbcast:7 row_mask:0xf bank_mask:0xf
v_and_b32_dpp v15, v34, v7 row_newbcast:7 row_mask:0xf bank_mask:0xf
s_cbranch_vccnz L_fb_173
s_waitcnt vmcnt(4)
L_fb_173:
s_waitcnt vmcnt(6)
buffer_load_dwordx4 v[116:119], v3, s[48:51], s9 offen nt
s_addk_i32 s9, 0x1000
v_mfma_f32_16x16x32_bf16 v[40:43], v[12:15], v[244:247], v[40:43]
v_and_b32_dpp v8, v34, v4 row_newbcast:11 row_mask:0xf bank_mask:0xf
v_and_b32_dpp v9, v34, v5 row_newbcast:11 row_mask:0xf bank_mask:0xf
v_and_b32_dpp v10, v34, v6 row_newbcast:11 row_mask:0xf bank_mask:0xf
v_and_b32_dpp v11, v34, v7 row_newbcast:11 row_mask:0xf bank_mask:0xf
s_cbranch_vccnz L_fb_174
s_waitcnt vmcnt(4)
L_fb_174:
s_waitcnt vmcnt(6)
buffer_load_dwordx4 v[120:123], v3, s[48:51], s9 offen nt
s_addk_i32 s9, 0x1000
v_mfma_f32_16x16x32_bf16 v[40:43], v[8:11], v[248:251], v[40:43]
v_and_b32_dpp v12, v34, v4 row_newbcast:15 row_mask:0xf bank_mask:0xf
v_and_b32_dpp v13, v34, v5 row_newbcast:15 row_mask:0xf bank_mask:0xf
v_and_b32_dpp v14, v34, v6 row_newbcast:15 row_mask:0xf bank_mask:0xf
v_and_b32_dpp v15, v34, v7 row_newbcast:15 row_mask:0xf bank_mask:0xf
s_cbranch_vccnz L_fb_175
s_waitcnt vmcnt(4)
L_fb_175:
s_waitcnt vmcnt(6)
buffer_load_dwordx4 v[124:127], v3, s[48:51], s9 offen nt
s_addk_i32 s9, 0x1000
v_mfma_f32_16x16x32_bf16 v[40:43], v[12:15], v[252:255], v[40:43]
v_and_b32_dpp v8, v35, v4 row_newbcast:0 row_mask:0xf bank_mask:0xf
v_and_b32_dpp v9, v35, v5 row_newbcast:0 row_mask:0xf bank_mask:0xf
v_and_b32_dpp v10, v35, v6 row_newbcast:0 row_mask:0xf bank_mask:0xf
v_and_b32_dpp v11, v35, v7 row_newbcast:0 row_mask:0xf bank_mask:0xf
s_waitcnt lgkmcnt(0)
s_sub_u32 s60, s60, s62
s_cmp_gt_u32 s60, 2795
s_cselect_b64 vcc, -1, 0
s_cbranch_vccnz L_fb_176
s_waitcnt vmcnt(4)
L_fb_176:
s_waitcnt vmcnt(6)
buffer_load_dwordx4 v[128:131], v3, s[48:51], s9 offen nt
s_addk_i32 s9, 0x1000
v_mfma_f32_16x16x32_bf16 v[40:43], v[8:11], v[80:83], v[40:43]
v_and_b32_dpp v12, v35, v4 row_newbcast:4 row_mask:0xf bank_mask:0xf
v_and_b32_dpp v13, v35, v5 row_newbcast:4 row_mask:0xf bank_mask:0xf
v_and_b32_dpp v14, v35, v6 row_newbcast:4 row_mask:0xf bank_mask:0xf
v_and_b32_dpp v15, v35, v7 row_newbcast:4 row_mask:0xf bank_mask:0xf
s_cbranch_vccnz L_fb_177
s_waitcnt vmcnt(4)
L_fb_177:
s_waitcnt vmcnt(6)
buffer_load_dwordx4 v[132:135], v3, s[48:51], s9 offen nt
s_addk_i32 s9, 0x1000
v_mfma_f32_16x16x32_bf16 v[40:43], v[12:15], v[84:87], v[40:43]
v_and_b32_dpp v8, v35, v4 row_newbcast:8 row_mask:0xf bank_mask:0xf
v_and_b32_dpp v9, v35, v5 row_newbcast:8 row_mask:0xf bank_mask:0xf
v_and_b32_dpp v10, v35, v6 row_newbcast:8 row_mask:0xf bank_mask:0xf
v_and_b32_dpp v11, v35, v7 row_newbcast:8 row_mask:0xf bank_mask:0xf
s_cbranch_vccnz L_fb_178
s_waitcnt vmcnt(4)
L_fb_178:
s_waitcnt vmcnt(6)
buffer_load_dwordx4 v[136:139], v3, s[48:51], s9 offen nt
s_addk_i32 s9, 0x1000
v_mfma_f32_16x16x32_bf16 v[40:43], v[8:11], v[88:91], v[40:43]
v_and_b32_dpp v12, v35, v4 row_newbcast:12 row_mask:0xf bank_mask:0xf
v_and_b32_dpp v13, v35, v5 row_newbcast:12 row_mask:0xf bank_mask:0xf
v_and_b32_dpp v14, v35, v6 row_newbcast:12 row_mask:0xf bank_mask:0xf
v_and_b32_dpp v15, v35, v7 row_newbcast:12 row_mask:0xf bank_mask:0xf
s_cbranch_vccnz L_fb_179
s_waitcnt vmcnt(4)
L_fb_179:
s_waitcnt vmcnt(6)
buffer_load_dwordx4 v[140:143], v3, s[48:51], s9 offen nt
s_addk_i32 s9, 0x1000
v_mfma_f32_16x16x32_bf16 v[40:43], v[12:15], v[92:95], v[40:43]
v_and_b32_dpp v8, v35, v4 row_newbcast:1 row_mask:0xf bank_mask:0xf
v_and_b32_dpp v9, v35, v5 row_newbcast:1 row_mask:0xf bank_mask:0xf
v_and_b32_dpp v10, v35, v6 row_newbcast:1 row_mask:0xf bank_mask:0xf
v_and_b32_dpp v11, v35, v7 row_newbcast:1 row_mask:0xf bank_mask:0xf
s_cbranch_vccnz L_fb_180
s_waitcnt vmcnt(4)
L_fb_180:
s_waitcnt vmcnt(6)
buffer_load_dwordx4 v[144:147], v3, s[48:51], s9 offen nt
s_addk_i32 s9, 0x1000
v_mfma_f32_16x16x32_bf16 v[40:43], v[8:11], v[96:99], v[40:43]
v_and_b32_dpp v12, v35, v4 row_newbcast:5 row_mask:0xf bank_mask:0xf
v_and_b32_dpp v13, v35, v5 row_newbcast:5 row_mask:0xf bank_mask:0xf
v_and_b32_dpp v14, v35, v6 row_newbcast:5 row_mask:0xf bank_mask:0xf
v_and_b32_dpp v15, v35, v7 row_newbcast:5 row_mask:0xf bank_mask:0xf
s_cbranch_vccnz L_fb_181
s_waitcnt vmcnt(4)
L_fb_181:
s_waitcnt vmcnt(6)
buffer_load_dwordx4 v[148:151], v3, s[48:51], s9 offen nt
s_addk_i32 s9, 0x1000
v_mfma_f32_16x16x32_bf16 v[40:43], v[12:15], v[100:103], v[40:43]
v_and_b32_dpp v8, v35, v4 row_newbcast:9 row_mask:0xf bank_mask:0xf
v_and_b32_dpp v9, v35, v5 row_newbcast:9 row_mask:0xf bank_mask:0xf
v_and_b32_dpp v10, v35, v6 row_newbcast:9 row_mask:0xf bank_mask:0xf
v_and_b32_dpp v11, v35, v7 row_newbcast:9 row_mask:0xf bank_mask:0xf
s_cbranch_vccnz L_fb_182
s_waitcnt vmcnt(4)
L_fb_182:
s_waitcnt vmcnt(6)
buffer_load_dwordx4 v[152:155], v3, s[48:51], s9 offen nt
s_addk_i32 s9, 0x1000
v_mfma_f32_16x16x32_bf16 v[40:43], v[8:11], v[104:107], v[40:43]
v_and_b32_dpp v12, v35, v4 row_newbcast:13 row_mask:0xf bank_mask:0xf
v_and_b32_dpp v13, v35, v5 row_newbcast:13 row_mask:0xf bank_mask:0xf
v_and_b32_dpp v14, v35, v6 row_newbcast:13 row_mask:0xf bank_mask:0xf
v_and_b32_dpp v15, v35, v7 row_newbcast:13 row_mask:0xf bank_mask:0xf
s_cbranch_vccnz L_fb_183
s_waitcnt vmcnt(4)
L_fb_183:
s_waitcnt vmcnt(6)
buffer_load_dwordx4 v[156:159], v3, s[48:51], s9 offen nt
s_addk_i32 s9, 0x1000
v_mfma_f32_16x16x32_bf16 v[40:43], v[12:15], v[108:111], v[40:43]
v_and_b32_dpp v8, v35, v4 row_newbcast:2 row_mask:0xf bank_mask:0xf
v_and_b32_dpp v9, v35, v5 row_newbcast:2 row_mask:0xf bank_mask:0xf
v_and_b32_dpp v10, v35, v6 row_newbcast:2 row_mask:0xf bank_mask:0xf
v_and_b32_dpp v11, v35, v7 row_newbcast:2 row_mask:0xf bank_mask:0xf
s_cbranch_vccnz L_fb_184
s_waitcnt vmcnt(4)
L_fb_184:
s_waitcnt vmcnt(6)
buffer_load_dwordx4 v[160:163], v3, s[48:51], s9 offen nt
s_addk_i32 s9, 0x1000
v_mfma_f32_16x16x32_bf16 v[40:43], v[8:11], v[112:115], v[40:43]
v_and_b32_dpp v12, v35, v4 row_newbcast:6 row_mask:0xf bank_mask:0xf
v_and_b32_dpp v13, v35, v5 row_newbcast:6 row_mask:0xf bank_mask:0xf
v_and_b32_dpp v14, v35, v6 row_newbcast:6 row_mask:0xf bank_mask:0xf
v_and_b32_dpp v15, v35, v7 row_newbcast:6 row_mask:0xf bank_mask:0xf
s_cbranch_vccnz L_fb_185
s_waitcnt vmcnt(4)
L_fb_185:
s_waitcnt vmcnt(6)
buffer_load_dwordx4 v[164:167], v3, s[48:51], s9 offen nt
s_addk_i32 s9, 0x1000
v_mfma_f32_16x16x32_bf16 v[40:43], v[12:15], v[116:119], v[40:43]
v_and_b32_dpp v8, v35, v4 row_newbcast:10 row_mask:0xf bank_mask:0xf
v_and_b32_dpp v9, v35, v5 row_newbcast:10 row_mask:0xf bank_mask:0xf
v_and_b32_dpp v10, v35, v6 row_newbcast:10 row_mask:0xf bank_mask:0xf
v_and_b32_dpp v11, v35, v7 row_newbcast:10 row_mask:0xf bank_mask:0xf
s_cbranch_vccnz L_fb_186
s_waitcnt vmcnt(4)
L_fb_186:
s_waitcnt vmcnt(6)
buffer_load_dwordx4 v[168:171], v3, s[48:51], s9 offen nt
s_addk_i32 s9, 0x1000
v_mfma_f32_16x16x32_bf16 v[40:43], v[8:11], v[120:123], v[40:43]
v_and_b32_dpp v12, v35, v4 row_newbcast:14 row_mask:0xf bank_mask:0xf
v_and_b32_dpp v13, v35, v5 row_newbcast:14 row_mask:0xf bank_mask:0xf
v_and_b32_dpp v14, v35, v6 row_newbcast:14 row_mask:0xf bank_mask:0xf
v_and_b32_dpp v15, v35, v7 row_newbcast:14 row_mask:0xf bank_mask:0xf
s_cbranch_vccnz L_fb_187
s_waitcnt vmcnt(4)
L_fb_187:
s_waitcnt vmcnt(6)
buffer_load_dwordx4 v[172:175], v3, s[48:51], s9 offen nt
s_addk_i32 s9, 0x1000
v_mfma_f32_16x16x32_bf16 v[40:43], v[12:15], v[124:127], v[40:43]
v_and_b32_dpp v8, v35, v4 row_newbcast:3 row_mask:0xf bank_mask:0xf
v_and_b32_dpp v9, v35, v5 row_newbcast:3 row_mask:0xf bank_mask:0xf
v_and_b32_dpp v10, v35, v6 row_newbcast:3 row_mask:0xf bank_mask:0xf
v_and_b32_dpp v11, v35, v7 row_newbcast:3 row_mask:0xf bank_mask:0xf
s_memrealtime s[60:61]
s_cbranch_vccnz L_fb_188
s_waitcnt vmcnt(4)
L_fb_188:
s_waitcnt vmcnt(6)
buffer_load_dwordx4 v[176:179], v3, s[48:51], s9 offen nt
s_addk_i32 s9, 0x1000
v_mfma_f32_16x16x32_bf16 v[40:43], v[8:11], v[128:131], v[40:43]
v_and_b32_dpp v12, v35, v4 row_newbcast:7 row_mask:0xf bank_mask:0xf
v_and_b32_dpp v13, v35, v5 row_newbcast:7 row_mask:0xf bank_mask:0xf
v_and_b32_dpp v14, v35, v6 row_newbcast:7 row_mask:0xf bank_mask:0xf
v_and_b32_dpp v15, v35, v7 row_newbcast:7 row_mask:0xf bank_mask:0xf
s_cbranch_vccnz L_fb_189
s_waitcnt vmcnt(4)
L_fb_189:
s_waitcnt vmcnt(6)
buffer_load_dwordx4 v[180:183], v3, s[48:51], s9 offen nt
s_addk_i32 s9, 0x1000
v_mfma_f32_16x16x32_bf16 v[40:43], v[12:15], v[132:135], v[40:43]
v_and_b32_dpp v8, v35, v4 row_newbcast:11 row_mask:0xf bank_mask:0xf
v_and_b32_dpp v9, v35, v5 row_newbcast:11 row_mask:0xf bank_mask:0xf
v_and_b32_dpp v10, v35, v6 row_newbcast:11 row_mask:0xf bank_mask:0xf
v_and_b32_dpp v11, v35, v7 row_newbcast:11 row_mask:0xf bank_mask:0xf
s_cbranch_vccnz L_fb_190
s_waitcnt vmcnt(4)
L_fb_190:
s_waitcnt vmcnt(6)
buffer_load_dwordx4 v[184:187], v3, s[48:51], s9 offen nt
s_addk_i32 s9, 0x1000
v_mfma_f32_16x16x32_bf16 v[40:43], v[8:11], v[136:139], v[40:43]
v_and_b32_dpp v12, v35, v4 row_newbcast:15 row_mask:0xf bank_mask:0xf
v_and_b32_dpp v13, v35, v5 row_newbcast:15 row_mask:0xf bank_mask:0xf
v_and_b32_dpp v14, v35, v6 row_newbcast:15 row_mask:0xf bank_mask:0xf
v_and_b32_dpp v15, v35, v7 row_newbcast:15 row_mask:0xf bank_mask:0xf
s_cbranch_vccnz L_fb_191
s_waitcnt vmcnt(4)
L_fb_191:
s_waitcnt vmcnt(6)
buffer_load_dwordx4 v[188:191], v3, s[48:51], s9 offen nt
s_addk_i32 s9, 0x1000
v_mfma_f32_16x16x32_bf16 v[40:43], v[12:15], v[140:143], v[40:43]
v_and_b32_dpp v8, v36, v4 row_newbcast:0 row_mask:0xf bank_mask:0xf
v_and_b32_dpp v9, v36, v5 row_newbcast:0 row_mask:0xf bank_mask:0xf
v_and_b32_dpp v10, v36, v6 row_newbcast:0 row_mask:0xf bank_mask:0xf
v_and_b32_dpp v11, v36, v7 row_newbcast:0 row_mask:0xf bank_mask:0xf
s_waitcnt lgkmcnt(0)
s_sub_u32 s60, s60, s62
s_cmp_gt_u32 s60, 3010
s_cselect_b64 vcc, -1, 0
s_cbranch_vccnz L_fb_192
s_waitcnt vmcnt(4)
L_fb_192:
s_waitcnt vmcnt(6)
buffer_load_dwordx4 v[192:195], v3, s[48:51], s9 offen nt
s_addk_i32 s9, 0x1000
v_mfma_f32_16x16x32_bf16 v[40:43], v[8:11], v[144:147], v[40:43]
v_and_b32_dpp v12, v36, v4 row_newbcast:4 row_mask:0xf bank_mask:0xf
v_and_b32_dpp v13, v36, v5 row_newbcast:4 row_mask:0xf bank_mask:0xf
v_and_b32_dpp v14, v36, v6 row_newbcast:4 row_mask:0xf bank_mask:0xf
v_and_b32_dpp v15, v36, v7 row_newbcast:4 row_mask:0xf bank_mask:0xf
s_cbranch_vccnz L_fb_193
s_waitcnt vmcnt(4)
L_fb_193:
s_waitcnt vmcnt(6)
buffer_load_dwordx4 v[196:199], v3, s[48:51], s9 offen nt
s_addk_i32 s9, 0x1000
v_mfma_f32_16x16x32_bf16 v[40:43], v[12:15], v[148:151], v[40:43]
v_and_b32_dpp v8, v36, v4 row_newbcast:8 row_mask:0xf bank_mask:0xf
v_and_b32_dpp v9, v36, v5 row_newbcast:8 row_mask:0xf bank_mask:0xf
v_and_b32_dpp v10, v36, v6 row_newbcast:8 row_mask:0xf bank_mask:0xf
v_and_b32_dpp v11, v36, v7 row_newbcast:8 row_mask:0xf bank_mask:0xf
s_cbranch_vccnz L_fb_194
s_waitcnt vmcnt(4)
L_fb_194:
s_waitcnt vmcnt(6)
buffer_load_dwordx4 v[200:203], v3, s[48:51], s9 offen nt
s_addk_i32 s9, 0x1000
v_mfma_f32_16x16x32_bf16 v[40:43], v[8:11], v[152:155], v[40:43]
v_and_b32_dpp v12, v36, v4 row_newbcast:12 row_mask:0xf bank_mask:0xf
v_and_b32_dpp v13, v36, v5 row_newbcast:12 row_mask:0xf bank_mask:0xf
v_and_b32_dpp v14, v36, v6 row_newbcast:12 row_mask:0xf bank_mask:0xf
v_and_b32_dpp v15, v36, v7 row_newbcast:12 row_mask:0xf bank_mask:0xf
s_cbranch_vccnz L_fb_195
s_waitcnt vmcnt(4)
L_fb_195:
s_waitcnt vmcnt(6)
buffer_load_dwordx4 v[204:207], v3, s[48:51], s9 offen nt
s_addk_i32 s9, 0x1000
v_mfma_f32_16x16x32_bf16 v[40:43], v[12:15], v[156:159], v[40:43]
v_and_b32_dpp v8, v36, v4 row_newbcast:1 row_mask:0xf bank_mask:0xf
v_and_b32_dpp v9, v36, v5 row_newbcast:1 row_mask:0xf bank_mask:0xf
v_and_b32_dpp v10, v36, v6 row_newbcast:1 row_mask:0xf bank_mask:0xf
v_and_b32_dpp v11, v36, v7 row_newbcast:1 row_mask:0xf bank_mask:0xf
s_cbranch_vccnz L_fb_196
s_waitcnt vmcnt(4)
L_fb_196:
s_waitcnt vmcnt(6)
buffer_load_dwordx4 v[208:211], v3, s[48:51], s9 offen nt
s_addk_i32 s9, 0x1000
v_mfma_f32_16x16x32_bf16 v[40:43], v[8:11], v[160:163], v[40:43]
v_and_b32_dpp v12, v36, v4 row_newbcast:5 row_mask:0xf bank_mask:0xf
v_and_b32_dpp v13, v36, v5 row_newbcast:5 row_mask:0xf bank_mask:0xf
v_and_b32_dpp v14, v36, v6 row_newbcast:5 row_mask:0xf bank_mask:0xf
v_and_b32_dpp v15, v36, v7 row_newbcast:5 row_mask:0xf bank_mask:0xf
s_cbranch_vccnz L_fb_197
s_waitcnt vmcnt(4)
L_fb_197:
s_waitcnt vmcnt(6)
buffer_load_dwordx4 v[212:215], v3, s[48:51], s9 offen nt
s_addk_i32 s9, 0x1000
v_mfma_f32_16x16x32_bf16 v[40:43], v[12:15], v[164:167], v[40:43]
v_and_b32_dpp v8, v36, v4 row_newbcast:9 row_mask:0xf bank_mask:0xf
v_and_b32_dpp v9, v36, v5 row_newbcast:9 row_mask:0xf bank_mask:0xf
v_and_b32_dpp v10, v36, v6 row_newbcast:9 row_mask:0xf bank_mask:0xf
v_and_b32_dpp v11, v36, v7 row_newbcast:9 row_mask:0xf bank_mask:0xf
s_cbranch_vccnz L_fb_198
s_waitcnt vmcnt(4)
L_fb_198:
s_waitcnt vmcnt(6)
buffer_load_dwordx4 v[216:219], v3, s[48:51], s9 offen nt
s_addk_i32 s9, 0x1000
v_mfma_f32_16x16x32_bf16 v[40:43], v[8:11], v[168:171], v[40:43]
v_and_b32_dpp v12, v36, v4 row_newbcast:13 row_mask:0xf bank_mask:0xf
v_and_b32_dpp v13, v36, v5 row_newbcast:13 row_mask:0xf bank_mask:0xf
v_and_b32_dpp v14, v36, v6 row_newbcast:13 row_mask:0xf bank_mask:0xf
v_and_b32_dpp v15, v36, v7 row_newbcast:13 row_mask:0xf bank_mask:0xf
s_cbranch_vccnz L_fb_199
s_waitcnt vmcnt(4)
L_fb_199:
s_waitcnt vmcnt(6)
buffer_load_dwordx4 v[220:223], v3, s[48:51], s9 offen nt
s_addk_i32 s9, 0x1000
v_mfma_f32_16x16x32_bf16 v[40:43], v[12:15], v[172:175], v[40:43]
v_and_b32_dpp v8, v36, v4 row_newbcast:2 row_mask:0xf bank_mask:0xf
v_and_b32_dpp v9, v36, v5 row_newbcast:2 row_mask:0xf bank_mask:0xf
v_and_b32_dpp v10, v36, v6 row_newbcast:2 row_mask:0xf bank_mask:0xf
v_and_b32_dpp v11, v36, v7 row_newbcast:2 row_mask:0xf bank_mask:0xf
s_cbranch_vccnz L_fb_200
s_waitcnt vmcnt(4)
L_fb_200:
s_waitcnt vmcnt(6)
buffer_load_dwordx4 v[224:227], v3, s[48:51], s9 offen nt
s_addk_i32 s9, 0x1000
v_mfma_f32_16x16x32_bf16 v[40:43], v[8:11], v[176:179], v[40:43]
v_and_b32_dpp v12, v36, v4 row_newbcast:6 row_mask:0xf bank_mask:0xf
v_and_b32_dpp v13, v36, v5 row_newbcast:6 row_mask:0xf bank_mask:0xf
v_and_b32_dpp v14, v36, v6 row_newbcast:6 row_mask:0xf bank_mask:0xf
v_and_b32_dpp v15, v36, v7 row_newbcast:6 row_mask:0xf bank_mask:0xf
s_cbranch_vccnz L_fb_201
s_waitcnt vmcnt(4)
L_fb_201:
s_waitcnt vmcnt(6)
buffer_load_dwordx4 v[228:231], v3, s[48:51], s9 offen nt
s_addk_i32 s9, 0x1000
v_mfma_f32_16x16x32_bf16 v[40:43], v[12:15], v[180:183], v[40:43]
v_and_b32_dpp v8, v36, v4 row_newbcast:10 row_mask:0xf bank_mask:0xf
v_and_b32_dpp v9, v36, v5 row_newbcast:10 row_mask:0xf bank_mask:0xf
v_and_b32_dpp v10, v36, v6 row_newbcast:10 row_mask:0xf bank_mask:0xf
v_and_b32_dpp v11, v36, v7 row_newbcast:10 row_mask:0xf bank_mask:0xf
s_cbranch_vccnz L_fb_202
s_waitcnt vmcnt(4)
L_fb_202:
s_waitcnt vmcnt(6)
buffer_load_dwordx4 v[232:235], v3, s[48:51], s9 offen nt
s_addk_i32 s9, 0x1000
v_mfma_f32_16x16x32_bf16 v[40:43], v[8:11], v[184:187], v[40:43]
v_and_b32_dpp v12, v36, v4 row_newbcast:14 row_mask:0xf bank_mask:0xf
v_and_b32_dpp v13, v36, v5 row_newbcast:14 row_mask:0xf bank_mask:0xf
v_and_b32_dpp v14, v36, v6 row_newbcast:14 row_mask:0xf bank_mask:0xf
v_and_b32_dpp v15, v36, v7 row_newbcast:14 row_mask:0xf bank_mask:0xf
s_cbranch_vccnz L_fb_203
s_waitcnt vmcnt(4)
L_fb_203:
s_waitcnt vmcnt(6)
buffer_load_dwordx4 v[236:239], v3, s[48:51], s9 offen nt
s_addk_i32 s9, 0x1000
v_mfma_f32_16x16x32_bf16 v[40:43], v[12:15], v[188:191], v[40:43]
v_and_b32_dpp v8, v36, v4 row_newbcast:3 row_mask:0xf bank_mask:0xf
v_and_b32_dpp v9, v36, v5 row_newbcast:3 row_mask:0xf bank_mask:0xf
v_and_b32_dpp v10, v36, v6 row_newbcast:3 row_mask:0xf bank_mask:0xf
v_and_b32_dpp v11, v36, v7 row_newbcast:3 row_mask:0xf bank_mask:0xf
s_memrealtime s[60:61]
s_cbranch_vccnz L_fb_204
s_waitcnt vmcnt(4)
L_fb_204:
s_waitcnt vmcnt(6)
buffer_load_dwordx4 v[240:243], v3, s[48:51], s9 offen nt
s_addk_i32 s9, 0x1000
v_mfma_f32_16x16x32_bf16 v[40:43], v[8:11], v[192:195], v[40:43]
v_and_b32_dpp v12, v36, v4 row_newbcast:7 row_mask:0xf bank_mask:0xf
v_and_b32_dpp v13, v36, v5 row_newbcast:7 row_mask:0xf bank_mask:0xf
v_and_b32_dpp v14, v36, v6 row_newbcast:7 row_mask:0xf bank_mask:0xf
v_and_b32_dpp v15, v36, v7 row_newbcast:7 row_mask:0xf bank_mask:0xf
s_cbranch_vccnz L_fb_205
s_waitcnt vmcnt(4)
L_fb_205:
s_waitcnt vmcnt(6)
buffer_load_dwordx4 v[244:247], v3, s[48:51], s9 offen nt
s_addk_i32 s9, 0x1000
v_mfma_f32_16x16x32_bf16 v[40:43], v[12:15], v[196:199], v[40:43]
v_and_b32_dpp v8, v36, v4 row_newbcast:11 row_mask:0xf bank_mask:0xf
v_and_b32_dpp v9, v36, v5 row_newbcast:11 row_mask:0xf bank_mask:0xf
v_and_b32_dpp v10, v36, v6 row_newbcast:11 row_mask:0xf bank_mask:0xf
v_and_b32_dpp v11, v36, v7 row_newbcast:11 row_mask:0xf bank_mask:0xf
s_cbranch_vccnz L_fb_206
s_waitcnt vmcnt(4)
L_fb_206:
s_waitcnt vmcnt(6)
buffer_load_dwordx4 v[248:251], v3, s[48:51], s9 offen nt
s_addk_i32 s9, 0x1000
v_mfma_f32_16x16x32_bf16 v[40:43], v[8:11], v[200:203], v[40:43]
v_and_b32_dpp v12, v36, v4 row_newbcast:15 row_mask:0xf bank_mask:0xf
v_and_b32_dpp v13, v36, v5 row_newbcast:15 row_mask:0xf bank_mask:0xf
v_and_b32_dpp v14, v36, v6 row_newbcast:15 row_mask:0xf bank_mask:0xf
v_and_b32_dpp v15, v36, v7 row_newbcast:15 row_mask:0xf bank_mask:0xf
s_cbranch_vccnz L_fb_207
s_waitcnt vmcnt(4)
L_fb_207:
s_waitcnt vmcnt(6)
buffer_load_dwordx4 v[252:255], v3, s[48:51], s9 offen nt
s_addk_i32 s9, 0x1000
v_mfma_f32_16x16x32_bf16 v[40:43], v[12:15], v[204:207], v[40:43]
v_and_b32_dpp v8, v37, v4 row_newbcast:0 row_mask:0xf bank_mask:0xf
v_and_b32_dpp v9, v37, v5 row_newbcast:0 row_mask:0xf bank_mask:0xf
v_and_b32_dpp v10, v37, v6 row_newbcast:0 row_mask:0xf bank_mask:0xf
v_and_b32_dpp v11, v37, v7 row_newbcast:0 row_mask:0xf bank_mask:0xf
s_waitcnt lgkmcnt(0)
s_sub_u32 s60, s60, s62
s_cmp_gt_u32 s60, 3230
s_cselect_b64 vcc, -1, 0
s_cbranch_vccnz L_fb_208
s_waitcnt vmcnt(4)
L_fb_208:
s_waitcnt vmcnt(6)
buffer_load_dwordx4 v[80:83], v3, s[48:51], s9 offen nt
s_addk_i32 s9, 0x1000
v_mfma_f32_16x16x32_bf16 v[40:43], v[8:11], v[208:211], v[40:43]
v_and_b32_dpp v12, v37, v4 row_newbcast:4 row_mask:0xf bank_mask:0xf
v_and_b32_dpp v13, v37, v5 row_newbcast:4 row_mask:0xf bank_mask:0xf
v_and_b32_dpp v14, v37, v6 row_newbcast:4 row_mask:0xf bank_mask:0xf
v_and_b32_dpp v15, v37, v7 row_newbcast:4 row_mask:0xf bank_mask:0xf
s_cbranch_vccnz L_fb_209
s_waitcnt vmcnt(4)
L_fb_209:
s_waitcnt vmcnt(6)
buffer_load_dwordx4 v[84:87], v3, s[48:51], s9 offen nt
s_addk_i32 s9, 0x1000
v_mfma_f32_16x16x32_bf16 v[40:43], v[12:15], v[212:215], v[40:43]
v_and_b32_dpp v8, v37, v4 row_newbcast:8 row_mask:0xf bank_mask:0xf
v_and_b32_dpp v9, v37, v5 row_newbcast:8 row_mask:0xf bank_mask:0xf
v_and_b32_dpp v10, v37, v6 row_newbcast:8 row_mask:0xf bank_mask:0xf
v_and_b32_dpp v11, v37, v7 row_newbcast:8 row_mask:0xf bank_mask:0xf
s_cbranch_vccnz L_fb_210
s_waitcnt vmcnt(4)
L_fb_210:
s_waitcnt vmcnt(6)
buffer_load_dwordx4 v[88:91], v3, s[48:51], s9 offen nt
s_addk_i32 s9, 0x1000
v_mfma_f32_16x16x32_bf16 v[40:43], v[8:11], v[216:219], v[40:43]
v_and_b32_dpp v12, v37, v4 row_newbcast:12 row_mask:0xf bank_mask:0xf
v_and_b32_dpp v13, v37, v5 row_newbcast:12 row_mask:0xf bank_mask:0xf
v_and_b32_dpp v14, v37, v6 row_newbcast:12 row_mask:0xf bank_mask:0xf
v_and_b32_dpp v15, v37, v7 row_newbcast:12 row_mask:0xf bank_mask:0xf
s_cbranch_vccnz L_fb_211
s_waitcnt vmcnt(4)
L_fb_211:
s_waitcnt vmcnt(6)
buffer_load_dwordx4 v[92:95], v3, s[48:51], s9 offen nt
s_addk_i32 s9, 0x1000
v_mfma_f32_16x16x32_bf16 v[40:43], v[12:15], v[220:223], v[40:43]
v_and_b32_dpp v8, v37, v4 row_newbcast:1 row_mask:0xf bank_mask:0xf
v_and_b32_dpp v9, v37, v5 row_newbcast:1 row_mask:0xf bank_mask:0xf
v_and_b32_dpp v10, v37, v6 row_newbcast:1 row_mask:0xf bank_mask:0xf
v_and_b32_dpp v11, v37, v7 row_newbcast:1 row_mask:0xf bank_mask:0xf
s_cbranch_vccnz L_fb_212
s_waitcnt vmcnt(4)
L_fb_212:
s_waitcnt vmcnt(6)
buffer_load_dwordx4 v[96:99], v3, s[48:51], s9 offen nt
s_addk_i32 s9, 0x1000
v_mfma_f32_16x16x32_bf16 v[40:43], v[8:11], v[224:227], v[40:43]
v_and_b32_dpp v12, v37, v4 row_newbcast:5 row_mask:0xf bank_mask:0xf
v_and_b32_dpp v13, v37, v5 row_newbcast:5 row_mask:0xf bank_mask:0xf
v_and_b32_dpp v14, v37, v6 row_newbcast:5 row_mask:0xf bank_mask:0xf
v_and_b32_dpp v15, v37, v7 row_newbcast:5 row_mask:0xf bank_mask:0xf
s_cbranch_vccnz L_fb_213
s_waitcnt vmcnt(4)
L_fb_213:
s_waitcnt vmcnt(6)
buffer_load_dwordx4 v[100:103], v3, s[48:51], s9 offen nt
s_addk_i32 s9, 0x1000
v_mfma_f32_16x16x32_bf16 v[40:43], v[12:15], v[228:231], v[40:43]
v_and_b32_dpp v8, v37, v4 row_newbcast:9 row_mask:0xf bank_mask:0xf
v_and_b32_dpp v9, v37, v5 row_newbcast:9 row_mask:0xf bank_mask:0xf
v_and_b32_dpp v10, v37, v6 row_newbcast:9 row_mask:0xf bank_mask:0xf
v_and_b32_dpp v11, v37, v7 row_newbcast:9 row_mask:0xf bank_mask:0xf
s_cbranch_vccnz L_fb_214
s_waitcnt vmcnt(4)
L_fb_214:
s_waitcnt vmcnt(6)
buffer_load_dwordx4 v[104:107], v3, s[48:51], s9 offen nt
s_addk_i32 s9, 0x1000
v_mfma_f32_16x16x32_bf16 v[40:43], v[8:11], v[232:235], v[40:43]
v_and_b32_dpp v12, v37, v4 row_newbcast:13 row_mask:0xf bank_mask:0xf
v_and_b32_dpp v13, v37, v5 row_newbcast:13 row_mask:0xf bank_mask:0xf
v_and_b32_dpp v14, v37, v6 row_newbcast:13 row_mask:0xf bank_mask:0xf
v_and_b32_dpp v15, v37, v7 row_newbcast:13 row_mask:0xf bank_mask:0xf
s_cbranch_vccnz L_fb_215
s_waitcnt vmcnt(4)
L_fb_215:
s_waitcnt vmcnt(6)
buffer_load_dwordx4 v[108:111], v3, s[48:51], s9 offen nt
s_addk_i32 s9, 0x1000
v_mfma_f32_16x16x32_bf16 v[40:43], v[12:15], v[236:239], v[40:43]
v_and_b32_dpp v8, v37, v4 row_newbcast:2 row_mask:0xf bank_mask:0xf
v_and_b32_dpp v9, v37, v5 row_newbcast:2 row_mask:0xf bank_mask:0xf
v_and_b32_dpp v10, v37, v6 row_newbcast:2 row_mask:0xf bank_mask:0xf
v_and_b32_dpp v11, v37, v7 row_newbcast:2 row_mask:0xf bank_mask:0xf
s_cbranch_vccnz L_fb_216
s_waitcnt vmcnt(4)
L_fb_216:
s_waitcnt vmcnt(6)
buffer_load_dwordx4 v[112:115], v3, s[48:51], s9 offen nt
s_addk_i32 s9, 0x1000
v_mfma_f32_16x16x32_bf16 v[40:43], v[8:11], v[240:243], v[40:43]
v_and_b32_dpp v12, v37, v4 row_newbcast:6 row_mask:0xf bank_mask:0xf
v_and_b32_dpp v13, v37, v5 row_newbcast:6 row_mask:0xf bank_mask:0xf
v_and_b32_dpp v14, v37, v6 row_newbcast:6 row_mask:0xf bank_mask:0xf
v_and_b32_dpp v15, v37, v7 row_newbcast:6 row_mask:0xf bank_mask:0xf
s_cbranch_vccnz L_fb_217
s_waitcnt vmcnt(4)
L_fb_217:
s_waitcnt vmcnt(6)
buffer_load_dwordx4 v[116:119], v3, s[48:51], s9 offen nt
s_addk_i32 s9, 0x1000
v_mfma_f32_16x16x32_bf16 v[40:43], v[12:15], v[244:247], v[40:43]
v_and_b32_dpp v8, v37, v4 row_newbcast:10 row_mask:0xf bank_mask:0xf
v_and_b32_dpp v9, v37, v5 row_newbcast:10 row_mask:0xf bank_mask:0xf
v_and_b32_dpp v10, v37, v6 row_newbcast:10 row_mask:0xf bank_mask:0xf
v_and_b32_dpp v11, v37, v7 row_newbcast:10 row_mask:0xf bank_mask:0xf
s_cbranch_vccnz L_fb_218
s_waitcnt vmcnt(4)
L_fb_218:
s_waitcnt vmcnt(6)
buffer_load_dwordx4 v[120:123], v3, s[48:51], s9 offen nt
s_addk_i32 s9, 0x1000
v_mfma_f32_16x16x32_bf16 v[40:43], v[8:11], v[248:251], v[40:43]
v_and_b32_dpp v12, v37, v4 row_newbcast:14 row_mask:0xf bank_mask:0xf
v_and_b32_dpp v13, v37, v5 row_newbcast:14 row_mask:0xf bank_mask:0xf
v_and_b32_dpp v14, v37, v6 row_newbcast:14 row_mask:0xf bank_mask:0xf
v_and_b32_dpp v15, v37, v7 row_newbcast:14 row_mask:0xf bank_mask:0xf
s_cbranch_vccnz L_fb_219
s_waitcnt vmcnt(4)
L_fb_219:
s_waitcnt vmcnt(6)
buffer_load_dwordx4 v[124:127], v3, s[48:51], s9 offen nt
s_addk_i32 s9, 0x1000
v_mfma_f32_16x16x32_bf16 v[40:43], v[12:15], v[252:255], v[40:43]
v_and_b32_dpp v8, v37, v4 row_newbcast:3 row_mask:0xf bank_mask:0xf
v_and_b32_dpp v9, v37, v5 row_newbcast:3 row_mask:0xf bank_mask:0xf
v_and_b32_dpp v10, v37, v6 row_newbcast:3 row_mask:0xf bank_mask:0xf
v_and_b32_dpp v11, v37, v7 row_newbcast:3 row_mask:0xf bank_mask:0xf
s_memrealtime s[60:61]
s_cbranch_vccnz L_fb_220
s_waitcnt vmcnt(4)
L_fb_220:
s_waitcnt vmcnt(6)
buffer_load_dwordx4 v[128:131], v3, s[48:51], s9 offen nt
s_addk_i32 s9, 0x1000
v_mfma_f32_16x16x32_bf16 v[40:43], v[8:11], v[80:83], v[40:43]
v_and_b32_dpp v12, v37, v4 row_newbcast:7 row_mask:0xf bank_mask:0xf
v_and_b32_dpp v13, v37, v5 row_newbcast:7 row_mask:0xf bank_mask:0xf
v_and_b32_dpp v14, v37, v6 row_newbcast:7 row_mask:0xf bank_mask:0xf
v_and_b32_dpp v15, v37, v7 row_newbcast:7 row_mask:0xf bank_mask:0xf
s_cbranch_vccnz L_fb_221
s_waitcnt vmcnt(4)
L_fb_221:
s_waitcnt vmcnt(6)
buffer_load_dwordx4 v[132:135], v3, s[48:51], s9 offen nt
s_addk_i32 s9, 0x1000
v_mfma_f32_16x16x32_bf16 v[40:43], v[12:15], v[84:87], v[40:43]
v_and_b32_dpp v8, v37, v4 row_newbcast:11 row_mask:0xf bank_mask:0xf
v_and_b32_dpp v9, v37, v5 row_newbcast:11 row_mask:0xf bank_mask:0xf
v_and_b32_dpp v10, v37, v6 row_newbcast:11 row_mask:0xf bank_mask:0xf
v_and_b32_dpp v11, v37, v7 row_newbcast:11 row_mask:0xf bank_mask:0xf
s_cbranch_vccnz L_fb_222
s_waitcnt vmcnt(4)
L_fb_222:
s_waitcnt vmcnt(6)
buffer_load_dwordx4 v[136:139], v3, s[48:51], s9 offen nt
s_addk_i32 s9, 0x1000
v_mfma_f32_16x16x32_bf16 v[40:43], v[8:11], v[88:91], v[40:43]
v_and_b32_dpp v12, v37, v4 row_newbcast:15 row_mask:0xf bank_mask:0xf
v_and_b32_dpp v13, v37, v5 row_newbcast:15 row_mask:0xf bank_mask:0xf
v_and_b32_dpp v14, v37, v6 row_newbcast:15 row_mask:0xf bank_mask:0xf
v_and_b32_dpp v15, v37, v7 row_newbcast:15 row_mask:0xf bank_mask:0xf
s_cbranch_vccnz L_fb_223
s_waitcnt vmcnt(4)
L_fb_223:
s_waitcnt vmcnt(6)
buffer_load_dwordx4 v[140:143], v3, s[48:51], s9 offen nt
s_addk_i32 s9, 0x1000
v_mfma_f32_16x16x32_bf16 v[40:43], v[12:15], v[92:95], v[40:43]
v_and_b32_dpp v8, v38, v4 row_newbcast:0 row_mask:0xf bank_mask:0xf
v_and_b32_dpp v9, v38, v5 row_newbcast:0 row_mask:0xf bank_mask:0xf
v_and_b32_dpp v10, v38, v6 row_newbcast:0 row_mask:0xf bank_mask:0xf
v_and_b32_dpp v11, v38, v7 row_newbcast:0 row_mask:0xf bank_mask:0xf
s_waitcnt lgkmcnt(0)
s_sub_u32 s60, s60, s62
s_cmp_gt_u32 s60, 3450
s_cselect_b64 vcc, -1, 0
s_cbranch_vccnz L_fb_224
s_waitcnt vmcnt(4)
L_fb_224:
s_waitcnt vmcnt(6)
buffer_load_dwordx4 v[144:147], v3, s[48:51], s9 offen nt
s_addk_i32 s9, 0x1000
v_mfma_f32_16x16x32_bf16 v[40:43], v[8:11], v[96:99], v[40:43]
v_and_b32_dpp v12, v38, v4 row_newbcast:4 row_mask:0xf bank_mask:0xf
v_and_b32_dpp v13, v38, v5 row_newbcast:4 row_mask:0xf bank_mask:0xf
v_and_b32_dpp v14, v38, v6 row_newbcast:4 row_mask:0xf bank_mask:0xf
v_and_b32_dpp v15, v38, v7 row_newbcast:4 row_mask:0xf bank_mask:0xf
s_cbranch_vccnz L_fb_225
s_waitcnt vmcnt(4)
L_fb_225:
s_waitcnt vmcnt(6)
buffer_load_dwordx4 v[148:151], v3, s[48:51], s9 offen nt
s_addk_i32 s9, 0x1000
v_mfma_f32_16x16x32_bf16 v[40:43], v[12:15], v[100:103], v[40:43]
v_and_b32_dpp v8, v38, v4 row_newbcast:8 row_mask:0xf bank_mask:0xf
v_and_b32_dpp v9, v38, v5 row_newbcast:8 row_mask:0xf bank_mask:0xf
v_and_b32_dpp v10, v38, v6 row_newbcast:8 row_mask:0xf bank_mask:0xf
v_and_b32_dpp v11, v38, v7 row_newbcast:8 row_mask:0xf bank_mask:0xf
s_cbranch_vccnz L_fb_226
s_waitcnt vmcnt(4)
L_fb_226:
s_waitcnt vmcnt(6)
buffer_load_dwordx4 v[152:155], v3, s[48:51], s9 offen nt
s_addk_i32 s9, 0x1000
v_mfma_f32_16x16x32_bf16 v[40:43], v[8:11], v[104:107], v[40:43]
v_and_b32_dpp v12, v38, v4 row_newbcast:12 row_mask:0xf bank_mask:0xf
v_and_b32_dpp v13, v38, v5 row_newbcast:12 row_mask:0xf bank_mask:0xf
v_and_b32_dpp v14, v38, v6 row_newbcast:12 row_mask:0xf bank_mask:0xf
v_and_b32_dpp v15, v38, v7 row_newbcast:12 row_mask:0xf bank_mask:0xf
s_cbranch_vccnz L_fb_227
s_waitcnt vmcnt(4)
L_fb_227:
s_waitcnt vmcnt(6)
buffer_load_dwordx4 v[156:159], v3, s[48:51], s9 offen nt
s_addk_i32 s9, 0x1000
v_mfma_f32_16x16x32_bf16 v[40:43], v[12:15], v[108:111], v[40:43]
v_and_b32_dpp v8, v38, v4 row_newbcast:1 row_mask:0xf bank_mask:0xf
v_and_b32_dpp v9, v38, v5 row_newbcast:1 row_mask:0xf bank_mask:0xf
v_and_b32_dpp v10, v38, v6 row_newbcast:1 row_mask:0xf bank_mask:0xf
v_and_b32_dpp v11, v38, v7 row_newbcast:1 row_mask:0xf bank_mask:0xf
s_cbranch_vccnz L_fb_228
s_waitcnt vmcnt(4)
L_fb_228:
s_waitcnt vmcnt(6)
buffer_load_dwordx4 v[160:163], v3, s[48:51], s9 offen nt
s_addk_i32 s9, 0x1000
v_mfma_f32_16x16x32_bf16 v[40:43], v[8:11], v[112:115], v[40:43]
v_and_b32_dpp v12, v38, v4 row_newbcast:5 row_mask:0xf bank_mask:0xf
v_and_b32_dpp v13, v38, v5 row_newbcast:5 row_mask:0xf bank_mask:0xf
v_and_b32_dpp v14, v38, v6 row_newbcast:5 row_mask:0xf bank_mask:0xf
v_and_b32_dpp v15, v38, v7 row_newbcast:5 row_mask:0xf bank_mask:0xf
s_cbranch_vccnz L_fb_229
s_waitcnt vmcnt(4)
L_fb_229:
s_waitcnt vmcnt(6)
buffer_load_dwordx4 v[164:167], v3, s[48:51], s9 offen nt
s_addk_i32 s9, 0x1000
v_mfma_f32_16x16x32_bf16 v[40:43], v[12:15], v[116:119], v[40:43]
v_and_b32_dpp v8, v38, v4 row_newbcast:9 row_mask:0xf bank_mask:0xf
v_and_b32_dpp v9, v38, v5 row_newbcast:9 row_mask:0xf bank_mask:0xf
v_and_b32_dpp v10, v38, v6 row_newbcast:9 row_mask:0xf bank_mask:0xf
v_and_b32_dpp v11, v38, v7 row_newbcast:9 row_mask:0xf bank_mask:0xf
s_cbranch_vccnz L_fb_230
s_waitcnt vmcnt(4)
L_fb_230:
s_waitcnt vmcnt(6)
buffer_load_dwordx4 v[168:171], v3, s[48:51], s9 offen nt
s_addk_i32 s9, 0x1000
v_mfma_f32_16x16x32_bf16 v[40:43], v[8:11], v[120:123], v[40:43]
v_and_b32_dpp v12, v38, v4 row_newbcast:13 row_mask:0xf bank_mask:0xf
v_and_b32_dpp v13, v38, v5 row_newbcast:13 row_mask:0xf bank_mask:0xf
v_and_b32_dpp v14, v38, v6 row_newbcast:13 row_mask:0xf bank_mask:0xf
v_and_b32_dpp v15, v38, v7 row_newbcast:13 row_mask:0xf bank_mask:0xf
s_cbranch_vccnz L_fb_231
s_waitcnt vmcnt(4)
L_fb_231:
s_waitcnt vmcnt(6)
buffer_load_dwordx4 v[172:175], v3, s[48:51], s9 offen nt
s_addk_i32 s9, 0x1000
v_mfma_f32_16x16x32_bf16 v[40:43], v[12:15], v[124:127], v[40:43]
v_and_b32_dpp v8, v38, v4 row_newbcast:2 row_mask:0xf bank_mask:0xf
v_and_b32_dpp v9, v38, v5 row_newbcast:2 row_mask:0xf bank_mask:0xf
v_and_b32_dpp v10, v38, v6 row_newbcast:2 row_mask:0xf bank_mask:0xf
v_and_b32_dpp v11, v38, v7 row_newbcast:2 row_mask:0xf bank_mask:0xf
s_cbranch_vccnz L_fb_232
s_waitcnt vmcnt(4)
L_fb_232:
s_waitcnt vmcnt(6)
buffer_load_dwordx4 v[176:179], v3, s[48:51], s9 offen nt
s_addk_i32 s9, 0x1000
v_mfma_f32_16x16x32_bf16 v[40:43], v[8:11], v[128:131], v[40:43]
v_and_b32_dpp v12, v38, v4 row_newbcast:6 row_mask:0xf bank_mask:0xf
v_and_b32_dpp v13, v38, v5 row_newbcast:6 row_mask:0xf bank_mask:0xf
v_and_b32_dpp v14, v38, v6 row_newbcast:6 row_mask:0xf bank_mask:0xf
v_and_b32_dpp v15, v38, v7 row_newbcast:6 row_mask:0xf bank_mask:0xf
s_cbranch_vccnz L_fb_233
s_waitcnt vmcnt(4)
L_fb_233:
s_waitcnt vmcnt(6)
buffer_load_dwordx4 v[180:183], v3, s[48:51], s9 offen nt
s_addk_i32 s9, 0x1000
v_mfma_f32_16x16x32_bf16 v[40:43], v[12:15], v[132:135], v[40:43]
v_and_b32_dpp v8, v38, v4 row_newbcast:10 row_mask:0xf bank_mask:0xf
v_and_b32_dpp v9, v38, v5 row_newbcast:10 row_mask:0xf bank_mask:0xf
v_and_b32_dpp v10, v38, v6 row_newbcast:10 row_mask:0xf bank_mask:0xf
v_and_b32_dpp v11, v38, v7 row_newbcast:10 row_mask:0xf bank_mask:0xf
s_cbranch_vccnz L_fb_234
s_waitcnt vmcnt(4)
L_fb_234:
s_waitcnt vmcnt(6)
buffer_load_dwordx4 v[184:187], v3, s[48:51], s9 offen nt
s_addk_i32 s9, 0x1000
v_mfma_f32_16x16x32_bf16 v[40:43], v[8:11], v[136:139], v[40:43]
v_and_b32_dpp v12, v38, v4 row_newbcast:14 row_mask:0xf bank_mask:0xf
v_and_b32_dpp v13, v38, v5 row_newbcast:14 row_mask:0xf bank_mask:0xf
v_and_b32_dpp v14, v38, v6 row_newbcast:14 row_mask:0xf bank_mask:0xf
v_and_b32_dpp v15, v38, v7 row_newbcast:14 row_mask:0xf bank_mask:0xf
s_cbranch_vccnz L_fb_235
s_waitcnt vmcnt(4)
L_fb_235:
s_waitcnt vmcnt(6)
buffer_load_dwordx4 v[188:191], v3, s[48:51], s9 offen nt
s_addk_i32 s9, 0x1000
v_mfma_f32_16x16x32_bf16 v[40:43], v[12:15], v[140:143], v[40:43]
v_and_b32_dpp v8, v38, v4 row_newbcast:3 row_mask:0xf bank_mask:0xf
v_and_b32_dpp v9, v38, v5 row_newbcast:3 row_mask:0xf bank_mask:0xf
v_and_b32_dpp v10, v38, v6 row_newbcast:3 row_mask:0xf bank_mask:0xf
v_and_b32_dpp v11, v38, v7 row_newbcast:3 row_mask:0xf bank_mask:0xf
s_memrealtime s[60:61]
s_cbranch_vccnz L_fb_236
s_waitcnt vmcnt(4)
L_fb_236:
s_waitcnt vmcnt(6)
buffer_load_dwordx4 v[192:195], v3, s[48:51], s9 offen nt
s_addk_i32 s9, 0x1000
v_mfma_f32_16x16x32_bf16 v[40:43], v[8:11], v[144:147], v[40:43]
v_and_b32_dpp v12, v38, v4 row_newbcast:7 row_mask:0xf bank_mask:0xf
v_and_b32_dpp v13, v38, v5 row_newbcast:7 row_mask:0xf bank_mask:0xf
v_and_b32_dpp v14, v38, v6 row_newbcast:7 row_mask:0xf bank_mask:0xf
v_and_b32_dpp v15, v38, v7 row_newbcast:7 row_mask:0xf bank_mask:0xf
s_cbranch_vccnz L_fb_237
s_waitcnt vmcnt(4)
L_fb_237:
s_waitcnt vmcnt(6)
buffer_load_dwordx4 v[196:199], v3, s[48:51], s9 offen nt
s_addk_i32 s9, 0x1000
v_mfma_f32_16x16x32_bf16 v[40:43], v[12:15], v[148:151], v[40:43]
v_and_b32_dpp v8, v38, v4 row_newbcast:11 row_mask:0xf bank_mask:0xf
v_and_b32_dpp v9, v38, v5 row_newbcast:11 row_mask:0xf bank_mask:0xf
v_and_b32_dpp v10, v38, v6 row_newbcast:11 row_mask:0xf bank_mask:0xf
v_and_b32_dpp v11, v38, v7 row_newbcast:11 row_mask:0xf bank_mask:0xf
s_cbranch_vccnz L_fb_238
s_waitcnt vmcnt(4)
L_fb_238:
s_waitcnt vmcnt(6)
buffer_load_dwordx4 v[200:203], v3, s[48:51], s9 offen nt
s_addk_i32 s9, 0x1000
v_mfma_f32_16x16x32_bf16 v[40:43], v[8:11], v[152:155], v[40:43]
v_and_b32_dpp v12, v38, v4 row_newbcast:15 row_mask:0xf bank_mask:0xf
v_and_b32_dpp v13, v38, v5 row_newbcast:15 row_mask:0xf bank_mask:0xf
v_and_b32_dpp v14, v38, v6 row_newbcast:15 row_mask:0xf bank_mask:0xf
v_and_b32_dpp v15, v38, v7 row_newbcast:15 row_mask:0xf bank_mask:0xf
s_cbranch_vccnz L_fb_239
s_waitcnt vmcnt(4)
L_fb_239:
s_waitcnt vmcnt(6)
buffer_load_dwordx4 v[204:207], v3, s[48:51], s9 offen nt
s_addk_i32 s9, 0x1000
v_mfma_f32_16x16x32_bf16 v[40:43], v[12:15], v[156:159], v[40:43]
v_and_b32_dpp v8, v39, v4 row_newbcast:0 row_mask:0xf bank_mask:0xf
v_and_b32_dpp v9, v39, v5 row_newbcast:0 row_mask:0xf bank_mask:0xf
v_and_b32_dpp v10, v39, v6 row_newbcast:0 row_mask:0xf bank_mask:0xf
v_and_b32_dpp v11, v39, v7 row_newbcast:0 row_mask:0xf bank_mask:0xf
s_waitcnt lgkmcnt(0)
s_sub_u32 s60, s60, s62
s_cmp_gt_u32 s60, 3670
s_cselect_b64 vcc, -1, 0
s_cbranch_vccnz L_fb_240
s_waitcnt vmcnt(4)
L_fb_240:
s_waitcnt vmcnt(6)
buffer_load_dwordx4 v[208:211], v3, s[48:51], s9 offen nt
s_addk_i32 s9, 0x1000
v_mfma_f32_16x16x32_bf16 v[40:43], v[8:11], v[160:163], v[40:43]
v_and_b32_dpp v12, v39, v4 row_newbcast:4 row_mask:0xf bank_mask:0xf
v_and_b32_dpp v13, v39, v5 row_newbcast:4 row_mask:0xf bank_mask:0xf
v_and_b32_dpp v14, v39, v6 row_newbcast:4 row_mask:0xf bank_mask:0xf
v_and_b32_dpp v15, v39, v7 row_newbcast:4 row_mask:0xf bank_mask:0xf
s_cbranch_vccnz L_fb_241
s_waitcnt vmcnt(4)
L_fb_241:
s_waitcnt vmcnt(6)
buffer_load_dwordx4 v[212:215], v3, s[48:51], s9 offen nt
s_addk_i32 s9, 0x1000
v_mfma_f32_16x16x32_bf16 v[40:43], v[12:15], v[164:167], v[40:43]
v_and_b32_dpp v8, v39, v4 row_newbcast:8 row_mask:0xf bank_mask:0xf
v_and_b32_dpp v9, v39, v5 row_newbcast:8 row_mask:0xf bank_mask:0xf
v_and_b32_dpp v10, v39, v6 row_newbcast:8 row_mask:0xf bank_mask:0xf
v_and_b32_dpp v11, v39, v7 row_newbcast:8 row_mask:0xf bank_mask:0xf
s_cbranch_vccnz L_fb_242
s_waitcnt vmcnt(4)
L_fb_242:
s_waitcnt vmcnt(6)
buffer_load_dwordx4 v[216:219], v3, s[48:51], s9 offen nt
s_addk_i32 s9, 0x1000
v_mfma_f32_16x16x32_bf16 v[40:43], v[8:11], v[168:171], v[40:43]
v_and_b32_dpp v12, v39, v4 row_newbcast:12 row_mask:0xf bank_mask:0xf
v_and_b32_dpp v13, v39, v5 row_newbcast:12 row_mask:0xf bank_mask:0xf
v_and_b32_dpp v14, v39, v6 row_newbcast:12 row_mask:0xf bank_mask:0xf
v_and_b32_dpp v15, v39, v7 row_newbcast:12 row_mask:0xf bank_mask:0xf
s_cbranch_vccnz L_fb_243
s_waitcnt vmcnt(4)
L_fb_243:
s_waitcnt vmcnt(6)
buffer_load_dwordx4 v[220:223], v3, s[48:51], s9 offen nt
s_addk_i32 s9, 0x1000
v_mfma_f32_16x16x32_bf16 v[40:43], v[12:15], v[172:175], v[40:43]
v_and_b32_dpp v8, v39, v4 row_newbcast:1 row_mask:0xf bank_mask:0xf
v_and_b32_dpp v9, v39, v5 row_newbcast:1 row_mask:0xf bank_mask:0xf
v_and_b32_dpp v10, v39, v6 row_newbcast:1 row_mask:0xf bank_mask:0xf
v_and_b32_dpp v11, v39, v7 row_newbcast:1 row_mask:0xf bank_mask:0xf
s_nop 1
v_mfma_f32_16x16x32_bf16 v[40:43], v[8:11], v[176:179], v[40:43]
v_and_b32_dpp v12, v39, v4 row_newbcast:5 row_mask:0xf bank_mask:0xf
v_and_b32_dpp v13, v39, v5 row_newbcast:5 row_mask:0xf bank_mask:0xf
v_and_b32_dpp v14, v39, v6 row_newbcast:5 row_mask:0xf bank_mask:0xf
v_and_b32_dpp v15, v39, v7 row_newbcast:5 row_mask:0xf bank_mask:0xf
s_nop 1
v_mfma_f32_16x16x32_bf16 v[40:43], v[12:15], v[180:183], v[40:43]
v_and_b32_dpp v8, v39, v4 row_newbcast:9 row_mask:0xf bank_mask:0xf
v_and_b32_dpp v9, v39, v5 row_newbcast:9 row_mask:0xf bank_mask:0xf
v_and_b32_dpp v10, v39, v6 row_newbcast:9 row_mask:0xf bank_mask:0xf
v_and_b32_dpp v11, v39, v7 row_newbcast:9 row_mask:0xf bank_mask:0xf
s_nop 1
v_mfma_f32_16x16x32_bf16 v[40:43], v[8:11], v[184:187], v[40:43]
v_and_b32_dpp v12, v39, v4 row_newbcast:13 row_mask:0xf bank_mask:0xf
v_and_b32_dpp v13, v39, v5 row_newbcast:13 row_mask:0xf bank_mask:0xf
v_and_b32_dpp v14, v39, v6 row_newbcast:13 row_mask:0xf bank_mask:0xf
v_and_b32_dpp v15, v39, v7 row_newbcast:13 row_mask:0xf bank_mask:0xf
s_nop 1
v_mfma_f32_16x16x32_bf16 v[40:43], v[12:15], v[188:191], v[40:43]
v_and_b32_dpp v8, v39, v4 row_newbcast:2 row_mask:0xf bank_mask:0xf
v_and_b32_dpp v9, v39, v5 row_newbcast:2 row_mask:0xf bank_mask:0xf
v_and_b32_dpp v10, v39, v6 row_newbcast:2 row_mask:0xf bank_mask:0xf
v_and_b32_dpp v11, v39, v7 row_newbcast:2 row_mask:0xf bank_mask:0xf
s_nop 1
v_mfma_f32_16x16x32_bf16 v[40:43], v[8:11], v[192:195], v[40:43]
v_and_b32_dpp v12, v39, v4 row_newbcast:6 row_mask:0xf bank_mask:0xf
v_and_b32_dpp v13, v39, v5 row_newbcast:6 row_mask:0xf bank_mask:0xf
v_and_b32_dpp v14, v39, v6 row_newbcast:6 row_mask:0xf bank_mask:0xf
v_and_b32_dpp v15, v39, v7 row_newbcast:6 row_mask:0xf bank_mask:0xf
s_waitcnt vmcnt(6)
s_nop 0
v_mfma_f32_16x16x32_bf16 v[40:43], v[12:15], v[196:199], v[40:43]
v_and_b32_dpp v8, v39, v4 row_newbcast:10 row_mask:0xf bank_mask:0xf
v_and_b32_dpp v9, v39, v5 row_newbcast:10 row_mask:0xf bank_mask:0xf
v_and_b32_dpp v10, v39, v6 row_newbcast:10 row_mask:0xf bank_mask:0xf
v_and_b32_dpp v11, v39, v7 row_newbcast:10 row_mask:0xf bank_mask:0xf
s_waitcnt vmcnt(5)
s_nop 0
v_mfma_f32_16x16x32_bf16 v[40:43], v[8:11], v[200:203], v[40:43]
v_and_b32_dpp v12, v39, v4 row_newbcast:14 row_mask:0xf bank_mask:0xf
v_and_b32_dpp v13, v39, v5 row_newbcast:14 row_mask:0xf bank_mask:0xf
v_and_b32_dpp v14, v39, v6 row_newbcast:14 row_mask:0xf bank_mask:0xf
v_and_b32_dpp v15, v39, v7 row_newbcast:14 row_mask:0xf bank_mask:0xf
s_waitcnt vmcnt(4)
s_nop 0
v_mfma_f32_16x16x32_bf16 v[40:43], v[12:15], v[204:207], v[40:43]
v_and_b32_dpp v8, v39, v4 row_newbcast:3 row_mask:0xf bank_mask:0xf
v_and_b32_dpp v9, v39, v5 row_newbcast:3 row_mask:0xf bank_mask:0xf
v_and_b32_dpp v10, v39, v6 row_newbcast:3 row_mask:0xf bank_mask:0xf
v_and_b32_dpp v11, v39, v7 row_newbcast:3 row_mask:0xf bank_mask:0xf
s_waitcnt vmcnt(3)
s_nop 0
v_mfma_f32_16x16x32_bf16 v[40:43], v[8:11], v[208:211], v[40:43]
v_and_b32_dpp v12, v39, v4 row_newbcast:7 row_mask:0xf bank_mask:0xf
v_and_b32_dpp v13, v39, v5 row_newbcast:7 row_mask:0xf bank_mask:0xf
v_and_b32_dpp v14, v39, v6 row_newbcast:7 row_mask:0xf bank_mask:0xf
v_and_b32_dpp v15, v39, v7 row_newbcast:7 row_mask:0xf bank_mask:0xf
s_waitcnt vmcnt(2)
s_nop 0
v_mfma_f32_16x16x32_bf16 v[40:43], v[12:15], v[212:215], v[40:43]
v_and_b32_dpp v8, v39, v4 row_newbcast:11 row_mask:0xf bank_mask:0xf
v_and_b32_dpp v9, v39, v5 row_newbcast:11 row_mask:0xf bank_mask:0xf
v_and_b32_dpp v10, v39, v6 row_newbcast:11 row_mask:0xf bank_mask:0xf
v_and_b32_dpp v11, v39, v7 row_newbcast:11 row_mask:0xf bank_mask:0xf
s_waitcnt vmcnt(1)
s_nop 0
v_mfma_f32_16x16x32_bf16 v[40:43], v[8:11], v[216:219], v[40:43]
v_and_b32_dpp v12, v39, v4 row_newbcast:15 row_mask:0xf bank_mask:0xf
v_and_b32_dpp v13, v39, v5 row_newbcast:15 row_mask:0xf bank_mask:0xf
v_and_b32_dpp v14, v39, v6 row_newbcast:15 row_mask:0xf bank_mask:0xf
v_and_b32_dpp v15, v39, v7 row_newbcast:15 row_mask:0xf bank_mask:0xf
s_waitcnt vmcnt(0)
s_nop 0
v_mfma_f32_16x16x32_bf16 v[40:43], v[12:15], v[220:223], v[40:43]
L_tail_S:
v_and_b32 v58, 15, v1
v_lshrrev_b32 v59, 4, v1
s_lshl_b32 s10, s4, 9
v_lshl_add_u32 v58, v58, 5, v57
v_lshl_add_u32 v58, v59, 4, v58
v_add_u32 v58, s10, v58
s_mov_b32 exec_hi, 0
s_nop 1
ds_write_b128 v58, v[40:43] offset:12800
s_mov_b32 exec_hi, -1
s_waitcnt lgkmcnt(0)
s_barrier
v_add_u32 v17, 256, v1
s_cmp_eq_u32 s4, 1
s_cbranch_scc1 L_pub_pre
s_cmp_eq_u32 s4, 2
s_cbranch_scc1 L_hop2
s_and_b32 s9, s2, 127
s_lshl_b32 s10, s4, 7
s_add_u32 s10, s10, s9
s_cmp_lt_u32 s10, 40
s_cbranch_scc1 L_reducer
s_barrier
s_branch L_mlp
L_reducer:
s_mul_i32 s10, s6, 655360
s_mul_i32 s42, s6, 40
s_add_u32 s42, s42, s9
s_lshl_b32 s11, s9, 7
s_add_u32 s10, s10, s11
s_add_u32 s10, s10, 262144
v_lshrrev_b32 v18, 3, v1
v_mul_u32_u24 v18, 5120, v18
v_and_b32 v17, 7, v1
v_lshl_add_u32 v16, v17, 4, v18
v_add_u32 v19, 40960, v16
v_add_u32 v24, 81920, v16
v_add_u32 v25, 122880, v16
s_add_u32 s11, s10, 163840
s_add_u32 s12, s10, 327680
s_add_u32 s13, s10, 491520
s_lshl_b32 s42, s42, 5
v_lshlrev_b32 v20, 2, v17
buffer_load_dword v21, v20, s[52:55], s42 offen
v_lshl_add_u32 v18, v17, 3, v18
v_and_b32 v17, 1, v1
v_cmp_eq_u32 vcc, 1, v17
v_mov_b32 v22, s92
v_mov_b32 v23, s93
v_cndmask_b32 v27, v22, v23, vcc
s_lshl_b32 s42, s42, 1
s_add_u32 s42, s42, 32768
s_barrier
s_sleep 30
buffer_load_dwordx4 v[80:83], v16, s[56:59], s10 offen sc1
buffer_load_dwordx4 v[84:87], v19, s[56:59], s10 offen sc1
buffer_load_dwordx4 v[88:91], v24, s[56:59], s10 offen sc1
buffer_load_dwordx4 v[92:95], v25, s[56:59], s10 offen sc1
buffer_load_dwordx4 v[96:99], v16, s[56:59], s11 offen sc1
buffer_load_dwordx4 v[100:103], v19, s[56:59], s11 offen sc1
buffer_load_dwordx4 v[104:107], v24, s[56:59], s11 offen sc1
buffer_load_dwordx4 v[108:111], v25, s[56:59], s11 offen sc1
buffer_load_dwordx4 v[112:115], v16, s[56:59], s12 offen sc1
buffer_load_dwordx4 v[116:119], v19, s[56:59], s12 offen sc1
buffer_load_dwordx4 v[120:123], v24, s[56:59], s12 offen sc1
buffer_load_dwordx4 v[124:127], v25, s[56:59], s12 offen sc1
buffer_load_dwordx4 v[128:131], v16, s[56:59], s13 offen sc1
buffer_load_dwordx4 v[132:135], v19, s[56:59], s13 offen sc1
buffer_load_dwordx4 v[136:139], v24, s[56:59], s13 offen sc1
buffer_load_dwordx4 v[140:143], v25, s[56:59], s13 offen sc1
s_mov_b32 s15, 200000
s_mov_b64 s[100:101], 0
s_waitcnt vmcnt(14)
v_sad_u32 v44, v81, s92, 0 clamp
v_sad_u32 v44, v83, s93, v44 clamp
v_sad_u32 v44, v85, s92, v44 clamp
v_sad_u32 v44, v87, s93, v44 clamp
v_cmp_ne_u32 vcc, 0, v44
v_add_f32 v28, v80, v84
v_add_f32 v29, v82, v86
s_mov_b64 s[16:17], vcc
s_or_b64 s[100:101], s[100:101], vcc
s_waitcnt vmcnt(12)
v_sad_u32 v44, v89, s92, 0 clamp
v_sad_u32 v44, v91, s93, v44 clamp
v_sad_u32 v44, v93, s92, v44 clamp
v_sad_u32 v44, v95, s93, v44 clamp
v_cmp_ne_u32 vcc, 0, v44
v_add_f32 v30, v88, v92
v_add_f32 v31, v90, v94
s_mov_b64 s[18:19], vcc
s_or_b64 s[100:101], s[100:101], vcc
s_waitcnt vmcnt(10)
v_sad_u32 v44, v97, s92, 0 clamp
v_sad_u32 v44, v99, s93, v44 clamp
v_sad_u32 v44, v101, s92, v44 clamp
v_sad_u32 v44, v103, s93, v44 clamp
v_cmp_ne_u32 vcc, 0, v44
v_add_f32 v32, v96, v100
v_add_f32 v33, v98, v102
s_mov_b64 s[20:21], vcc
s_or_b64 s[100:101], s[100:101], vcc
s_waitcnt vmcnt(8)
v_sad_u32 v44, v105, s92, 0 clamp
v_sad_u32 v44, v107, s93, v44 clamp
v_sad_u32 v44, v109, s92, v44 clamp
v_sad_u32 v44, v111, s93, v44 clamp
v_cmp_ne_u32 vcc, 0, v44
v_add_f32 v34, v104, v108
v_add_f32 v35, v106, v110
s_mov_b64 s[22:23], vcc
s_or_b64 s[100:101], s[100:101], vcc
s_waitcnt vmcnt(6)
v_sad_u32 v44, v113, s92, 0 clamp
v_sad_u32 v44, v115, s93, v44 clamp
v_sad_u32 v44, v117, s92, v44 clamp
v_sad_u32 v44, v119, s93, v44 clamp
v_cmp_ne_u32 vcc, 0, v44
v_add_f32 v36, v112, v116
v_add_f32 v37, v114, v118
s_mov_b64 s[24:25], vcc
s_or_b64 s[100:101], s[100:101], vcc
s_waitcnt vmcnt(4)
v_sad_u32 v44, v121, s92, 0 clamp
v_sad_u32 v44, v123, s93, v44 clamp
v_sad_u32 v44, v125, s92, v44 clamp
v_sad_u32 v44, v127, s93, v44 clamp
v_cmp_ne_u32 vcc, 0, v44
v_add_f32 v38, v120, v124
v_add_f32 v39, v122, v126
s_mov_b64 s[28:29], vcc
s_or_b64 s[100:101], s[100:101], vcc
s_waitcnt vmcnt(2)
v_sad_u32 v44, v129, s92, 0 clamp
v_sad_u32 v44, v131, s93, v44 clamp
v_sad_u32 v44, v133, s92, v44 clamp
v_sad_u32 v44, v135, s93, v44 clamp
v_cmp_ne_u32 vcc, 0, v44
v_add_f32 v40, v128, v132
v_add_f32 v41, v130, v134
s_mov_b64 s[30:31], vcc
s_or_b64 s[100:101], s[100:101], vcc
s_waitcnt vmcnt(0)
v_sad_u32 v44, v137, s92, 0 clamp
v_sad_u32 v44, v139, s93, v44 clamp
v_sad_u32 v44, v141, s92, v44 clamp
v_sad_u32 v44, v143, s93, v44 clamp
v_cmp_ne_u32 vcc, 0, v44
v_add_f32 v42, v136, v140
v_add_f32 v43, v138, v142
s_mov_b64 s[32:33], vcc
s_or_b64 s[100:101], s[100:101], vcc
s_cbranch_scc0 L_qpd_247
L_qp_246:
s_mov_b64 exec, s[16:17]
s_cbranch_execz L_qs_248
buffer_load_dwordx4 v[80:83], v16, s[56:59], s10 offen sc1
buffer_load_dwordx4 v[84:87], v19, s[56:59], s10 offen sc1
L_qs_248:
s_mov_b64 exec, s[18:19]
s_cbranch_execz L_qs_249
buffer_load_dwordx4 v[88:91], v24, s[56:59], s10 offen sc1
buffer_load_dwordx4 v[92:95], v25, s[56:59], s10 offen sc1
L_qs_249:
s_mov_b64 exec, s[20:21]
s_cbranch_execz L_qs_250
buffer_load_dwordx4 v[96:99], v16, s[56:59], s11 offen sc1
buffer_load_dwordx4 v[100:103], v19, s[56:59], s11 offen sc1
L_qs_250:
s_mov_b64 exec, s[22:23]
s_cbranch_execz L_qs_251
buffer_load_dwordx4 v[104:107], v24, s[56:59], s11 offen sc1
buffer_load_dwordx4 v[108:111], v25, s[56:59], s11 offen sc1
L_qs_251:
s_mov_b64 exec, s[24:25]
s_cbranch_execz L_qs_252
buffer_load_dwordx4 v[112:115], v16, s[56:59], s12 offen sc1
buffer_load_dwordx4 v[116:119], v19, s[56:59], s12 offen sc1
L_qs_252:
s_mov_b64 exec, s[28:29]
s_cbranch_execz L_qs_253
buffer_load_dwordx4 v[120:123], v24, s[56:59], s12 offen sc1
buffer_load_dwordx4 v[124:127], v25, s[56:59], s12 offen sc1
L_qs_253:
s_mov_b64 exec, s[30:31]
s_cbranch_execz L_qs_254
buffer_load_dwordx4 v[128:131], v16, s[56:59], s13 offen sc1
buffer_load_dwordx4 v[132:135], v19, s[56:59], s13 offen sc1
L_qs_254:
s_mov_b64 exec, s[32:33]
s_cbranch_execz L_qs_255
buffer_load_dwordx4 v[136:139], v24, s[56:59], s13 offen sc1
buffer_load_dwordx4 v[140:143], v25, s[56:59], s13 offen sc1
L_qs_255:
s_mov_b64 s[100:101], 0
s_waitcnt vmcnt(0)
s_mov_b64 exec, s[16:17]
s_cbranch_execz L_qc_256
v_sad_u32 v44, v81, s92, 0 clamp
v_sad_u32 v44, v83, s93, v44 clamp
v_sad_u32 v44, v85, s92, v44 clamp
v_sad_u32 v44, v87, s93, v44 clamp
v_cmp_ne_u32 vcc, 0, v44
v_add_f32 v28, v80, v84
v_add_f32 v29, v82, v86
s_mov_b64 s[16:17], vcc
s_or_b64 s[100:101], s[100:101], vcc
L_qc_256:
s_mov_b64 exec, s[18:19]
s_cbranch_execz L_qc_257
v_sad_u32 v44, v89, s92, 0 clamp
v_sad_u32 v44, v91, s93, v44 clamp
v_sad_u32 v44, v93, s92, v44 clamp
v_sad_u32 v44, v95, s93, v44 clamp
v_cmp_ne_u32 vcc, 0, v44
v_add_f32 v30, v88, v92
v_add_f32 v31, v90, v94
s_mov_b64 s[18:19], vcc
s_or_b64 s[100:101], s[100:101], vcc
L_qc_257:
s_mov_b64 exec, s[20:21]
s_cbranch_execz L_qc_258
v_sad_u32 v44, v97, s92, 0 clamp
v_sad_u32 v44, v99, s93, v44 clamp
v_sad_u32 v44, v101, s92, v44 clamp
v_sad_u32 v44, v103, s93, v44 clamp
v_cmp_ne_u32 vcc, 0, v44
v_add_f32 v32, v96, v100
v_add_f32 v33, v98, v102
s_mov_b64 s[20:21], vcc
s_or_b64 s[100:101], s[100:101], vcc
L_qc_258:
s_mov_b64 exec, s[22:23]
s_cbranch_execz L_qc_259
v_sad_u32 v44, v105, s92, 0 clamp
v_sad_u32 v44, v107, s93, v44 clamp
v_sad_u32 v44, v109, s92, v44 clamp
v_sad_u32 v44, v111, s93, v44 clamp
v_cmp_ne_u32 vcc, 0, v44
v_add_f32 v34, v104, v108
v_add_f32 v35, v106, v110
s_mov_b64 s[22:23], vcc
s_or_b64 s[100:101], s[100:101], vcc
L_qc_259:
s_mov_b64 exec, s[24:25]
s_cbranch_execz L_qc_260
v_sad_u32 v44, v113, s92, 0 clamp
v_sad_u32 v44, v115, s93, v44 clamp
v_sad_u32 v44, v117, s92, v44 clamp
v_sad_u32 v44, v119, s93, v44 clamp
v_cmp_ne_u32 vcc, 0, v44
v_add_f32 v36, v112, v116
v_add_f32 v37, v114, v118
s_mov_b64 s[24:25], vcc
s_or_b64 s[100:101], s[100:101], vcc
L_qc_260:
s_mov_b64 exec, s[28:29]
s_cbranch_execz L_qc_261
v_sad_u32 v44, v121, s92, 0 clamp
v_sad_u32 v44, v123, s93, v44 clamp
v_sad_u32 v44, v125, s92, v44 clamp
v_sad_u32 v44, v127, s93, v44 clamp
v_cmp_ne_u32 vcc, 0, v44
v_add_f32 v38, v120, v124
v_add_f32 v39, v122, v126
s_mov_b64 s[28:29], vcc
s_or_b64 s[100:101], s[100:101], vcc
L_qc_261:
s_mov_b64 exec, s[30:31]
s_cbranch_execz L_qc_262
v_sad_u32 v44, v129, s92, 0 clamp
v_sad_u32 v44, v131, s93, v44 clamp
v_sad_u32 v44, v133, s92, v44 clamp
v_sad_u32 v44, v135, s93, v44 clamp
v_cmp_ne_u32 vcc, 0, v44
v_add_f32 v40, v128, v132
v_add_f32 v41, v130, v134
s_mov_b64 s[30:31], vcc
s_or_b64 s[100:101], s[100:101], vcc
L_qc_262:
s_mov_b64 exec, s[32:33]
s_cbranch_execz L_qc_263
v_sad_u32 v44, v137, s92, 0 clamp
v_sad_u32 v44, v139, s93, v44 clamp
v_sad_u32 v44, v141, s92, v44 clamp
v_sad_u32 v44, v143, s93, v44 clamp
v_cmp_ne_u32 vcc, 0, v44
v_add_f32 v42, v136, v140
v_add_f32 v43, v138, v142
s_mov_b64 s[32:33], vcc
s_or_b64 s[100:101], s[100:101], vcc
L_qc_263:
s_sub_u32 s15, s15, 1
s_cbranch_scc1 L_qpd_247
s_cmp_lg_u64 s[100:101], 0
s_cbranch_scc1 L_qp_246
L_qpd_247:
s_mov_b64 exec, -1
v_pk_add_f32 v[28:29], v[28:29], v[36:37]
v_pk_add_f32 v[30:31], v[30:31], v[38:39]
v_pk_add_f32 v[32:33], v[32:33], v[40:41]
v_pk_add_f32 v[34:35], v[34:35], v[42:43]
v_pk_add_f32 v[28:29], v[28:29], v[32:33]
v_pk_add_f32 v[30:31], v[30:31], v[34:35]
v_pk_add_f32 v[28:29], v[28:29], v[30:31]
v_lshlrev_b32 v32, 16, v21
v_and_b32 v33, 0xffff0000, v21
v_add_f32_dpp v28, v28, v28 row_ror:8 row_mask:0xf bank_mask:0xf
v_add_f32_dpp v29, v29, v29 row_ror:8 row_mask:0xf bank_mask:0xf
v_mov_b32 v30, v28
v_mov_b32 v31, v29
s_nop 0
v_permlane16_swap_b32 v28, v30
v_permlane16_swap_b32 v29, v31
v_pk_add_f32 v[28:29], v[28:29], v[30:31]
v_mov_b32 v30, v28
v_mov_b32 v31, v29
s_nop 0
v_permlane32_swap_b32 v28, v30
v_permlane32_swap_b32 v29, v31
v_pk_add_f32 v[28:29], v[28:29], v[30:31]
v_cvt_pk_bf16_f32 v28, 0, v28
v_cvt_pk_bf16_f32 v29, 0, v29
v_pk_add_f32 v[28:29], v[28:29], v[32:33]
v_cvt_pk_bf16_f32 v26, v28, v29
buffer_store_dwordx2 v[26:27], v18, s[56:59], s42 offen sc1
s_mov_b64 exec, -1
s_branch L_mlp
L_hop2:
s_and_b32 s96, s2, 7
s_mul_i32 s96, s96, 5120
s_mul_i32 s97, s6, 2560
s_add_u32 s96, s96, s97
s_add_u32 s96, s96, 32768
v_lshlrev_b32 v26, 4, v1
v_lshlrev_b32 v27, 3, v1
v_and_b32 v28, 1, v1
v_cmp_eq_u32 vcc, 1, v28
v_mov_b32 v28, s92
v_mov_b32 v29, s93
v_cndmask_b32 v49, v28, v29, vcc
s_mov_b32 s15, 1600000
v_lshlrev_b32 v74, 1, v0
v_mov_b32 v60, 0
v_mov_b32 v61, 0
v_mov_b32 v62, 0
v_mov_b32 v63, 0
v_mov_b32 v64, 0
v_mov_b32 v65, 0
v_mov_b32 v66, 0
v_mov_b32 v67, 0
v_mov_b32 v68, 0
v_mov_b32 v69, 0
v_mov_b32 v70, 0
v_mov_b32 v71, 0
ds_read_u16_d16_hi v60, v74 offset:512
ds_read_u16_d16_hi v61, v74 offset:1536
ds_read_u16_d16_hi v62, v74 offset:2560
ds_read_u16_d16_hi v63, v74 offset:3584
ds_read_u16_d16_hi v64, v74 offset:4608
ds_read_u16_d16_hi v65, v74 offset:5632
ds_read_u16_d16_hi v66, v74 offset:6656
ds_read_u16_d16_hi v67, v74 offset:7680
ds_read_u16_d16_hi v68, v74 offset:8704
ds_read_u16_d16_hi v69, v74 offset:9728
ds_read_u16_d16_hi v70, v74 offset:10752
ds_read_u16_d16_hi v71, v74 offset:11776
s_and_b32 s9, s2, 127
s_mul_i32 s9, s9, 20
v_lshl_add_u32 v74, v1, 2, s9
v_lshrrev_b32 v77, 1, v74
s_mul_i32 s9, s6, 1280
v_add_u32 v77, s9, v77
v_mov_b32 v72, 0xc0135761
v_mov_b32 v73, 1.0
v_and_b32 v75, 15, v1
v_lshrrev_b32 v76, 4, v1
s_lshl_b32 s9, s3, 4
v_lshl_add_u32 v76, v76, 2, s9
v_mul_u32_u24 v75, 144, v75
v_add_u32 v76, v75, v76
s_mov_b32 s44, 0xaaaaaaaa
s_mov_b32 s45, 0xaaaaaaaa
s_mov_b32 s46, 0xcccccccc
s_mov_b32 s47, 0xcccccccc
s_mov_b32 s48, 0x000f000f
s_mov_b32 s49, 0x000f000f
s_mov_b32 s60, s36
s_mov_b32 s61, s37
s_mov_b32 s62, 2560
s_mov_b32 s63, 0x20000
s_lshl_b32 s9, s26, 16
v_lshrrev_b32 v75, 3, v1
v_and_b32 v79, 7, v1
v_sub_u32 v77, v77, v1
v_sub_u32 v77, v77, v1
v_lshl_add_u32 v77, v75, 1, v77
v_lshlrev_b32 v224, 2, v1
v_sub_u32 v224, v74, v224
v_lshl_add_u32 v224, v75, 2, v224
v_mul_u32_u24 v75, 144, v75
v_lshl_add_u32 v75, v79, 4, v75
s_mov_b32 s50, 0xbdd2d3e8
s_mov_b32 s51, 0xbe9e1eee
s_waitcnt lgkmcnt(0)
v_pk_mul_f32 v[216:217], v[60:61], v[60:61]
v_pk_mul_f32 v[220:221], v[64:65], v[64:65]
v_pk_mul_f32 v[200:201], v[216:217], s[50:51] op_sel_hi:[1,0]
v_pk_mul_f32 v[204:205], v[216:217], s[50:51] op_sel:[0,1] op_sel_hi:[1,1]
v_pk_fma_f32 v[208:209], v[220:221], s[50:51], v[72:73] op_sel:[0,1,0] op_sel_hi:[1,1,0]
v_pk_fma_f32 v[212:213], v[220:221], s[50:51], v[72:73] op_sel_hi:[1,0,0]
v_pk_mul_f32 v[200:201], v[200:201], v[60:61]
v_pk_mul_f32 v[204:205], v[204:205], v[64:65]
v_pk_mul_f32 v[208:209], v[208:209], v[60:61]
v_pk_mul_f32 v[212:213], v[212:213], v[64:65]
v_pk_mul_f32 v[216:217], v[60:61], v[68:69]
v_pk_mul_f32 v[220:221], v[64:65], v[68:69]
v_pk_mul_f32 v[218:219], v[62:63], v[62:63]
v_pk_mul_f32 v[222:223], v[66:67], v[66:67]
v_pk_mul_f32 v[202:203], v[218:219], s[50:51] op_sel_hi:[1,0]
v_pk_mul_f32 v[206:207], v[218:219], s[50:51] op_sel:[0,1] op_sel_hi:[1,1]
v_pk_fma_f32 v[210:211], v[222:223], s[50:51], v[72:73] op_sel:[0,1,0] op_sel_hi:[1,1,0]
v_pk_fma_f32 v[214:215], v[222:223], s[50:51], v[72:73] op_sel_hi:[1,0,0]
v_pk_mul_f32 v[202:203], v[202:203], v[62:63]
v_pk_mul_f32 v[206:207], v[206:207], v[66:67]
v_pk_mul_f32 v[210:211], v[210:211], v[62:63]
v_pk_mul_f32 v[214:215], v[214:215], v[66:67]
v_pk_mul_f32 v[218:219], v[62:63], v[70:71]
v_pk_mul_f32 v[222:223], v[66:67], v[70:71]
s_barrier
s_sleep 40
s_mov_b64 exec, 0xff
L_fw_264:
buffer_load_dwordx4 v[80:83], v26, s[56:59], s96 offen sc1
s_waitcnt vmcnt(0)
v_cmp_eq_u32 vcc, s92, v81
s_sub_u32 s15, s15, 1
s_cbranch_scc1 L_fwd_265
s_cbranch_vccnz L_fwd_265
s_sleep 2
s_branch L_fw_264
L_fwd_265:
s_mov_b64 exec, -1
buffer_load_dwordx4 v[80:83], v26, s[56:59], s96 offen sc1
buffer_load_dwordx4 v[84:87], v26, s[56:59], s96 offen offset:1024 sc1
buffer_load_dwordx2 v[88:89], v27, s[56:59], s96 offen offset:2048 sc1
s_mov_b32 s15, 200000
s_mov_b64 s[100:101], 0
s_waitcnt vmcnt(2)
v_sad_u32 v28, v81, s92, 0 clamp
v_sad_u32 v28, v83, s93, v28 clamp
v_cmp_ne_u32 vcc, 0, v28
v_lshlrev_b32 v30, 16, v80
v_and_b32 v31, 0xffff0000, v80
v_lshlrev_b32 v32, 16, v82
v_and_b32 v33, 0xffff0000, v82
s_mov_b64 s[16:17], vcc
s_or_b64 s[100:101], s[100:101], vcc
s_waitcnt vmcnt(1)
v_sad_u32 v28, v85, s92, 0 clamp
v_sad_u32 v28, v87, s93, v28 clamp
v_cmp_ne_u32 vcc, 0, v28
v_lshlrev_b32 v34, 16, v84
v_and_b32 v35, 0xffff0000, v84
v_lshlrev_b32 v36, 16, v86
v_and_b32 v37, 0xffff0000, v86
s_mov_b64 s[18:19], vcc
s_or_b64 s[100:101], s[100:101], vcc
s_waitcnt vmcnt(0)
v_cmp_ne_u32 vcc, v49, v89
v_lshlrev_b32 v38, 16, v88
v_and_b32 v39, 0xffff0000, v88
s_mov_b64 s[20:21], vcc
s_or_b64 s[100:101], s[100:101], vcc
s_cbranch_scc0 L_qpd_267
L_qp_266:
s_mov_b64 exec, s[16:17]
s_cbranch_execz L_qs_268
buffer_load_dwordx4 v[80:83], v26, s[56:59], s96 offen sc1
L_qs_268:
s_mov_b64 exec, s[18:19]
s_cbranch_execz L_qs_269
buffer_load_dwordx4 v[84:87], v26, s[56:59], s96 offen offset:1024 sc1
L_qs_269:
s_mov_b64 exec, s[20:21]
s_cbranch_execz L_qs_270
buffer_load_dwordx2 v[88:89], v27, s[56:59], s96 offen offset:2048 sc1
L_qs_270:
s_mov_b64 s[100:101], 0
s_waitcnt vmcnt(0)
s_mov_b64 exec, s[16:17]
s_cbranch_execz L_qc_271
v_sad_u32 v28, v81, s92, 0 clamp
v_sad_u32 v28, v83, s93, v28 clamp
v_cmp_ne_u32 vcc, 0, v28
v_lshlrev_b32 v30, 16, v80
v_and_b32 v31, 0xffff0000, v80
v_lshlrev_b32 v32, 16, v82
v_and_b32 v33, 0xffff0000, v82
s_mov_b64 s[16:17], vcc
s_or_b64 s[100:101], s[100:101], vcc
L_qc_271:
s_mov_b64 exec, s[18:19]
s_cbranch_execz L_qc_272
v_sad_u32 v28, v85, s92, 0 clamp
v_sad_u32 v28, v87, s93, v28 clamp
v_cmp_ne_u32 vcc, 0, v28
v_lshlrev_b32 v34, 16, v84
v_and_b32 v35, 0xffff0000, v84
v_lshlrev_b32 v36, 16, v86
v_and_b32 v37, 0xffff0000, v86
s_mov_b64 s[18:19], vcc
s_or_b64 s[100:101], s[100:101], vcc
L_qc_272:
s_mov_b64 exec, s[20:21]
s_cbranch_execz L_qc_273
v_cmp_ne_u32 vcc, v49, v89
v_lshlrev_b32 v38, 16, v88
v_and_b32 v39, 0xffff0000, v88
s_mov_b64 s[20:21], vcc
s_or_b64 s[100:101], s[100:101], vcc
L_qc_273:
s_sub_u32 s15, s15, 1
s_cbranch_scc1 L_qpd_267
s_cmp_lg_u64 s[100:101], 0
s_cbranch_scc1 L_qp_266
L_qpd_267:
s_mov_b64 exec, -1
s_nop 0
v_readfirstlane_b32 s42, v30
ds_write_b128 v26, v[30:33] offset:25088
ds_write_b128 v26, v[34:37] offset:26112
ds_write_b64 v27, v[38:39] offset:27136
v_pk_add_f32 v[40:41], v[30:31], s[42:43] op_sel_hi:[1,0] neg_lo:[0,1] neg_hi:[0,1]
v_pk_mul_f32 v[46:47], v[40:41], v[40:41]
v_pk_add_f32 v[42:43], v[32:33], s[42:43] op_sel_hi:[1,0] neg_lo:[0,1] neg_hi:[0,1]
v_pk_add_f32 v[44:45], v[40:41], v[42:43]
v_pk_fma_f32 v[46:47], v[42:43], v[42:43], v[46:47]
v_pk_add_f32 v[40:41], v[34:35], s[42:43] op_sel_hi:[1,0] neg_lo:[0,1] neg_hi:[0,1]
v_pk_add_f32 v[44:45], v[44:45], v[40:41]
v_pk_fma_f32 v[46:47], v[40:41], v[40:41], v[46:47]
v_pk_add_f32 v[42:43], v[36:37], s[42:43] op_sel_hi:[1,0] neg_lo:[0,1] neg_hi:[0,1]
v_pk_add_f32 v[44:45], v[44:45], v[42:43]
v_pk_fma_f32 v[46:47], v[42:43], v[42:43], v[46:47]
v_pk_add_f32 v[40:41], v[38:39], s[42:43] op_sel_hi:[1,0] neg_lo:[0,1] neg_hi:[0,1]
v_pk_add_f32 v[44:45], v[44:45], v[40:41]
v_pk_fma_f32 v[46:47], v[40:41], v[40:41], v[46:47]
v_add_f32 v44, v44, v45
v_add_f32 v46, v46, v47
v_mov_b32 v40, 0x3acccccd
v_mov_b32 v41, 0x3727c5ac
v_add_f32_dpp v44, v44, v44 quad_perm:[1,0,3,2] row_mask:0xf bank_mask:0xf
v_add_f32_dpp v46, v46, v46 quad_perm:[1,0,3,2] row_mask:0xf bank_mask:0xf
s_nop 0
v_add_f32_dpp v44, v44, v44 quad_perm:[2,3,0,1] row_mask:0xf bank_mask:0xf
v_add_f32_dpp v46, v46, v46 quad_perm:[2,3,0,1] row_mask:0xf bank_mask:0xf
s_nop 0
v_add_f32_dpp v44, v44, v44 row_half_mirror row_mask:0xf bank_mask:0xf
v_add_f32_dpp v46, v46, v46 row_half_mirror row_mask:0xf bank_mask:0xf
s_nop 0
v_add_f32_dpp v44, v44, v44 row_mirror row_mask:0xf bank_mask:0xf
v_add_f32_dpp v46, v46, v46 row_mirror row_mask:0xf bank_mask:0xf
s_nop 0
v_add_f32_dpp v44, v44, v44 row_bcast:15 row_mask:0xa bank_mask:0xf
v_add_f32_dpp v46, v46, v46 row_bcast:15 row_mask:0xa bank_mask:0xf
s_nop 0
v_add_f32_dpp v44, v44, v44 row_bcast:31 row_mask:0xc bank_mask:0xf
v_add_f32_dpp v46, v46, v46 row_bcast:31 row_mask:0xc bank_mask:0xf
s_nop 0
v_mul_f32 v44, v44, v40
v_mul_f32 v46, v46, v40
v_fma_f32 v46, -v44, v44, v46
v_add_f32 v44, s42, v44
v_max_f32 v46, 0, v46
v_add_f32 v42, v46, v41
v_rsq_f32 v42, v42
s_lshl_b64 exec, 1, 63
v_mul_f32 v46, v46, v42
v_fma_f32 v46, v46, v42, v41
v_rsq_f32 v46, v46
s_nop 0
v_mul_f32 v45, v46, v42
ds_write_b64 v57, v[44:45] offset:27648
s_mov_b64 exec, -1
s_cmp_lg_u32 s2, 0
s_cbranch_scc1 L_mlp_b
v_mov_b32 v20, s92
v_mov_b32 v21, s93
s_mov_b64 exec, 1
s_mov_b32 s11, 16384
buffer_store_dwordx2 v[20:21], off, s[56:59], s11 sc1
s_mov_b64 exec, -1
s_branch L_mlp_b
L_h123:
v_and_b32 v63, 1, v1
v_mov_b32 v64, 0xffff
v_cmp_eq_u32 vcc, 1, v63
v_mov_b32 v65, 0xffff0000
v_bfe_u32 v66, v1, 1, 3
v_cndmask_b32 v64, v64, v65, vcc
v_cmp_eq_u32 vcc, 0, v66
s_nop 1
v_cndmask_b32 v4, 0, v64, vcc
v_cmp_eq_u32 vcc, 1, v66
s_nop 1
v_cndmask_b32 v5, 0, v64, vcc
v_cmp_eq_u32 vcc, 2, v66
s_nop 1
v_cndmask_b32 v6, 0, v64, vcc
v_cmp_eq_u32 vcc, 3, v66
s_nop 1
v_cndmask_b32 v7, 0, v64, vcc
s_waitcnt lgkmcnt(0)
s_load_dword s26, s[34:35], 0
s_mov_b32 s56, s40
s_mov_b32 s57, s41
s_mov_b32 s58, 2097152
s_mov_b32 s59, 0x20000
s_mov_b32 s52, s16
s_mov_b32 s53, s17
s_mov_b32 s54, 2560
s_mov_b32 s55, 0x20000
s_mul_i32 s12, s4, 40960
v_lshrrev_b32 v59, 4, v1
v_and_b32 v60, 15, v1
v_mul_u32_u24 v3, 1280, v59
v_lshl_add_u32 v3, v60, 4, v3
v_add_u32 v3, s12, v3
s_mul_i32 s13, s5, 163840
s_add_u32 s48, s24, s13
s_addc_u32 s49, s25, 0
s_mov_b32 s50, 163840
s_mov_b32 s51, 0x20000
s_cmp_eq_u32 s4, 2
s_cselect_b32 s60, s30, s28
s_cselect_b32 s61, s31, s29
s_cmp_eq_u32 s4, 3
s_cselect_b32 s60, s32, s60
s_cselect_b32 s61, s33, s61
s_mov_b32 s62, 3456
s_mov_b32 s63, 0x20000
v_lshlrev_b32 v61, 4, v1
buffer_load_dwordx4 v[16:19], v61, s[60:63], 0 offen offset:0
buffer_load_dwordx4 v[20:23], v61, s[60:63], 0 offen offset:1024
buffer_load_dwordx4 v[24:27], v61, s[60:63], 0 offen offset:2048
buffer_load_dwordx4 v[28:31], v61, s[60:63], 0 offen offset:3072
v_mov_b32 v8, -1
v_mov_b32 v9, -1
v_mov_b32 v10, -1
v_mov_b32 v11, -1
s_mov_b64 exec, 15
ds_write_b128 v61, v[8:11] offset:256
s_mov_b64 exec, -1
s_sub_u32 s10, s4, 1
s_lshl_b32 s10, s10, 12
v_add_u32 v61, s10, v61
s_waitcnt vmcnt(0)
ds_write_b128 v61, v[16:19] offset:512
ds_write_b128 v61, v[20:23] offset:1536
ds_write_b128 v61, v[24:27] offset:2560
ds_write_b128 v61, v[28:31] offset:3584
s_waitcnt lgkmcnt(0)
s_barrier
v_mov_b32 v58, 0
ds_read_b64 v[58:59], v58 offset:320
s_waitcnt lgkmcnt(0)
v_readfirstlane_b32 s92, v58
v_readfirstlane_b32 s93, v59
L_hjoin:
s_mov_b32 s15, 800000
L_sw_277:
ds_read_b32 v61, v57 offset:288
s_waitcnt lgkmcnt(0)
v_cmp_eq_u32 vcc, -1, v61
s_sub_u32 s15, s15, 1
s_cbranch_scc1 L_swd_278
s_cbranch_vccz L_swd_278
s_sleep 8
s_branch L_sw_277
L_swd_278:
s_waitcnt vmcnt(2)
s_mov_b32 s9, 0
buffer_load_dwordx4 v[96:99], v3, s[48:51], s9 offen offset:0 nt
s_waitcnt vmcnt(2)
buffer_load_dwordx4 v[100:103], v3, s[48:51], s9 offen offset:256 nt
s_waitcnt vmcnt(2)
buffer_load_dwordx4 v[104:107], v3, s[48:51], s9 offen offset:512 nt
s_waitcnt vmcnt(2)
buffer_load_dwordx4 v[108:111], v3, s[48:51], s9 offen offset:768 nt
s_waitcnt vmcnt(2)
buffer_load_dwordx4 v[112:115], v3, s[48:51], s9 offen offset:1024 nt
s_waitcnt vmcnt(2)
s_mov_b32 s9, 5120
buffer_load_dwordx4 v[116:119], v3, s[48:51], s9 offen offset:0 nt
s_waitcnt vmcnt(2)
buffer_load_dwordx4 v[120:123], v3, s[48:51], s9 offen offset:256 nt
s_waitcnt vmcnt(2)
buffer_load_dwordx4 v[124:127], v3, s[48:51], s9 offen offset:512 nt
s_waitcnt vmcnt(2)
buffer_load_dwordx4 v[128:131], v3, s[48:51], s9 offen offset:768 nt
s_waitcnt vmcnt(2)
buffer_load_dwordx4 v[132:135], v3, s[48:51], s9 offen offset:1024 nt
s_waitcnt vmcnt(2)
s_mov_b32 s9, 10240
buffer_load_dwordx4 v[136:139], v3, s[48:51], s9 offen offset:0 nt
s_waitcnt vmcnt(2)
buffer_load_dwordx4 v[140:143], v3, s[48:51], s9 offen offset:256 nt
s_waitcnt vmcnt(2)
buffer_load_dwordx4 v[144:147], v3, s[48:51], s9 offen offset:512 nt
s_waitcnt vmcnt(2)
buffer_load_dwordx4 v[148:151], v3, s[48:51], s9 offen offset:768 nt
s_waitcnt vmcnt(2)
buffer_load_dwordx4 v[152:155], v3, s[48:51], s9 offen offset:1024 nt
s_waitcnt vmcnt(2)
s_mov_b32 s9, 15360
buffer_load_dwordx4 v[156:159], v3, s[48:51], s9 offen offset:0 nt
s_waitcnt vmcnt(2)
buffer_load_dwordx4 v[160:163], v3, s[48:51], s9 offen offset:256 nt
s_waitcnt vmcnt(2)
buffer_load_dwordx4 v[164:167], v3, s[48:51], s9 offen offset:512 nt
s_waitcnt vmcnt(2)
buffer_load_dwordx4 v[168:171], v3, s[48:51], s9 offen offset:768 nt
s_waitcnt vmcnt(2)
buffer_load_dwordx4 v[172:175], v3, s[48:51], s9 offen offset:1024 nt
s_waitcnt vmcnt(2)
s_mov_b32 s9, 20480
buffer_load_dwordx4 v[176:179], v3, s[48:51], s9 offen offset:0 nt
s_waitcnt vmcnt(2)
buffer_load_dwordx4 v[180:183], v3, s[48:51], s9 offen offset:256 nt
s_waitcnt vmcnt(2)
buffer_load_dwordx4 v[184:187], v3, s[48:51], s9 offen offset:512 nt
s_waitcnt vmcnt(2)
buffer_load_dwordx4 v[188:191], v3, s[48:51], s9 offen offset:768 nt
s_waitcnt vmcnt(2)
buffer_load_dwordx4 v[192:195], v3, s[48:51], s9 offen offset:1024 nt
s_waitcnt vmcnt(2)
s_mov_b32 s9, 25600
buffer_load_dwordx4 v[196:199], v3, s[48:51], s9 offen offset:0 nt
s_waitcnt vmcnt(2)
buffer_load_dwordx4 v[200:203], v3, s[48:51], s9 offen offset:256 nt
s_waitcnt vmcnt(2)
buffer_load_dwordx4 v[204:207], v3, s[48:51], s9 offen offset:512 nt
s_waitcnt vmcnt(2)
buffer_load_dwordx4 v[208:211], v3, s[48:51], s9 offen offset:768 nt
s_waitcnt vmcnt(2)
buffer_load_dwordx4 v[212:215], v3, s[48:51], s9 offen offset:1024 nt
s_waitcnt vmcnt(2)
s_mov_b32 s9, 30720
buffer_load_dwordx4 v[216:219], v3, s[48:51], s9 offen offset:0 nt
s_waitcnt vmcnt(2)
buffer_load_dwordx4 v[220:223], v3, s[48:51], s9 offen offset:256 nt
s_waitcnt vmcnt(2)
buffer_load_dwordx4 v[224:227], v3, s[48:51], s9 offen offset:512 nt
s_waitcnt vmcnt(2)
buffer_load_dwordx4 v[228:231], v3, s[48:51], s9 offen offset:768 nt
s_waitcnt vmcnt(2)
buffer_load_dwordx4 v[232:235], v3, s[48:51], s9 offen offset:1024 nt
s_waitcnt vmcnt(2)
s_mov_b32 s9, 35840
buffer_load_dwordx4 v[236:239], v3, s[48:51], s9 offen offset:0 nt
s_waitcnt vmcnt(2)
buffer_load_dwordx4 v[240:243], v3, s[48:51], s9 offen offset:256 nt
s_waitcnt vmcnt(2)
buffer_load_dwordx4 v[244:247], v3, s[48:51], s9 offen offset:512 nt
s_waitcnt vmcnt(2)
buffer_load_dwordx4 v[248:251], v3, s[48:51], s9 offen offset:768 nt
s_waitcnt vmcnt(2)
buffer_load_dwordx4 v[252:255], v3, s[48:51], s9 offen offset:1024 nt
s_cmp_lg_u32 s4, 1
s_cbranch_scc1 L_tail_H
v_and_b32 v58, 3, v1
v_lshlrev_b32 v59, 3, v58
s_mov_b32 s15, 800000
L_sw_279:
ds_read_b64 v[60:61], v59 offset:256
s_waitcnt lgkmcnt(0)
v_cmp_eq_u32 vcc, -1, v61
s_sub_u32 s15, s15, 1
s_cbranch_scc1 L_swd_280
s_cbranch_vccz L_swd_280
s_sleep 8
s_branch L_sw_279
L_swd_280:
v_mov_b32 v62, v61
v_mov_b32 v61, s92
v_mov_b32 v63, s93
v_lshlrev_b32 v64, 4, v1
s_lshl_b32 s11, s8, 7
s_add_u32 s11, s11, 131072
s_mov_b64 exec, 0xff
buffer_store_dwordx4 v[60:63], v64, s[56:59], s11 offen sc1
s_mov_b64 exec, -1
s_and_b32 s10, s8, 0xfc
s_lshl_b32 s10, s10, 7
s_add_u32 s10, s10, 131072
v_and_b32 v58, 3, v1
v_bfe_u32 v59, v1, 2, 2
v_lshlrev_b32 v58, 4, v58
v_lshl_add_u32 v58, v59, 7, v58
s_sleep 127
s_mov_b32 s15, 200000
L_poll_281:
buffer_load_dwordx4 v[66:69], v58, s[56:59], s10 offen sc1
s_waitcnt vmcnt(0)
v_xor_b32 v71, s92, v67
v_xor_b32 v72, s93, v69
v_or_b32 v70, v71, v72
v_cmp_ne_u32 vcc, 0, v70
s_sub_u32 s15, s15, 1
s_cbranch_scc1 L_pdone_282
s_cbranch_vccz L_pdone_282
s_sleep 32
s_branch L_poll_281
L_pdone_282:
v_mov_b32 v67, v68
v_mov_b32 v62, v66
s_nop 1
v_max_f32_dpp v62, v62, v62 quad_perm:[1,0,3,2] row_mask:0xf bank_mask:0xf
s_nop 1
v_max_f32_dpp v62, v62, v62 quad_perm:[2,3,0,1] row_mask:0xf bank_mask:0xf
s_nop 1
v_max_f32_dpp v62, v62, v62 row_half_mirror row_mask:0xf bank_mask:0xf
s_nop 1
v_max_f32_dpp v62, v62, v62 row_mirror row_mask:0xf bank_mask:0xf
v_sub_f32 v66, v66, v62
v_mul_f32 v66, 0x3fb8aa3b, v66
v_exp_f32 v66, v66
s_nop 0
v_mul_f32 v67, v66, v67
s_nop 1
v_add_f32_dpp v67, v67, v67 quad_perm:[1,0,3,2] row_mask:0xf bank_mask:0xf
s_nop 1
v_add_f32_dpp v67, v67, v67 quad_perm:[2,3,0,1] row_mask:0xf bank_mask:0xf
s_nop 1
v_add_f32_dpp v67, v67, v67 row_half_mirror row_mask:0xf bank_mask:0xf
s_nop 1
v_add_f32_dpp v67, v67, v67 row_mirror row_mask:0xf bank_mask:0xf
v_rcp_f32 v67, v67
s_lshl_b32 s10, s7, 2
v_mul_f32 v66, v66, v67
v_and_b32 v58, 3, v1
v_lshlrev_b32 v58, 2, v58
s_lshl_b64 exec, 15, s10
ds_write_b32 v58, v66 offset:336
s_mov_b64 exec, -1
s_waitcnt lgkmcnt(0)
L_tail_H:
v_and_b32 v16, 15, v1
v_lshrrev_b32 v17, 4, v1
s_lshl_b32 s10, s4, 7
v_lshl_add_u32 v18, v16, 4, v57
v_lshl_add_u32 v18, v17, 2, v18
v_add_u32 v18, s10, v18
s_mul_i32 s10, s4, 2560
v_lshl_add_u32 v16, v16, 5, v57
v_lshl_add_u32 v16, v17, 4, v16
v_add_u32 v16, s10, v16
s_lshl_b32 s10, s4, 6
v_add_u32 v17, s10, v1
v_lshlrev_b32 v19, 4, v17
v_lshl_add_u32 v92, v17, 3, v57
s_mul_i32 s11, s8, 5120
s_add_u32 s11, s11, 262144
v_mov_b32 v89, s92
v_mov_b32 v91, s93
s_waitcnt vmcnt(0)
s_barrier
ds_read_b32 v20, v18 offset:12800
ds_read_b32 v21, v18 offset:13312
ds_read_b32 v22, v18 offset:13824
ds_read_b32 v23, v18 offset:14336
ds_read_b128 v[24:27], v57 offset:336
s_waitcnt lgkmcnt(0)
v_mul_f32 v20, v24, v20
v_fmac_f32 v20, v25, v21
v_fmac_f32 v20, v26, v22
v_fmac_f32 v20, v27, v23
v_cvt_pk_bf16_f32 v20, v20, v20
s_nop 1
v_and_b32_dpp v24, v20, v4 row_newbcast:0 row_mask:0xf bank_mask:0xf
v_and_b32_dpp v25, v20, v5 row_newbcast:0 row_mask:0xf bank_mask:0xf
v_and_b32_dpp v26, v20, v6 row_newbcast:0 row_mask:0xf bank_mask:0xf
v_and_b32_dpp v27, v20, v7 row_newbcast:0 row_mask:0xf bank_mask:0xf
v_and_b32_dpp v28, v20, v4 row_newbcast:1 row_mask:0xf bank_mask:0xf
v_and_b32_dpp v29, v20, v5 row_newbcast:1 row_mask:0xf bank_mask:0xf
v_and_b32_dpp v30, v20, v6 row_newbcast:1 row_mask:0xf bank_mask:0xf
v_and_b32_dpp v31, v20, v7 row_newbcast:1 row_mask:0xf bank_mask:0xf
v_mfma_f32_16x16x32_bf16 v[60:63], v[24:27], v[96:99], 0
v_and_b32_dpp v32, v20, v4 row_newbcast:2 row_mask:0xf bank_mask:0xf
v_and_b32_dpp v33, v20, v5 row_newbcast:2 row_mask:0xf bank_mask:0xf
v_and_b32_dpp v34, v20, v6 row_newbcast:2 row_mask:0xf bank_mask:0xf
v_and_b32_dpp v35, v20, v7 row_newbcast:2 row_mask:0xf bank_mask:0xf
v_mfma_f32_16x16x32_bf16 v[60:63], v[28:31], v[116:119], v[60:63]
v_and_b32_dpp v36, v20, v4 row_newbcast:3 row_mask:0xf bank_mask:0xf
v_and_b32_dpp v37, v20, v5 row_newbcast:3 row_mask:0xf bank_mask:0xf
v_and_b32_dpp v38, v20, v6 row_newbcast:3 row_mask:0xf bank_mask:0xf
v_and_b32_dpp v39, v20, v7 row_newbcast:3 row_mask:0xf bank_mask:0xf
v_mfma_f32_16x16x32_bf16 v[60:63], v[32:35], v[136:139], v[60:63]
v_and_b32_dpp v40, v20, v4 row_newbcast:4 row_mask:0xf bank_mask:0xf
v_and_b32_dpp v41, v20, v5 row_newbcast:4 row_mask:0xf bank_mask:0xf
v_and_b32_dpp v42, v20, v6 row_newbcast:4 row_mask:0xf bank_mask:0xf
v_and_b32_dpp v43, v20, v7 row_newbcast:4 row_mask:0xf bank_mask:0xf
v_mfma_f32_16x16x32_bf16 v[60:63], v[36:39], v[156:159], v[60:63]
v_and_b32_dpp v44, v20, v4 row_newbcast:5 row_mask:0xf bank_mask:0xf
v_and_b32_dpp v45, v20, v5 row_newbcast:5 row_mask:0xf bank_mask:0xf
v_and_b32_dpp v46, v20, v6 row_newbcast:5 row_mask:0xf bank_mask:0xf
v_and_b32_dpp v47, v20, v7 row_newbcast:5 row_mask:0xf bank_mask:0xf
v_mfma_f32_16x16x32_bf16 v[60:63], v[40:43], v[176:179], v[60:63]
v_and_b32_dpp v48, v20, v4 row_newbcast:6 row_mask:0xf bank_mask:0xf
v_and_b32_dpp v49, v20, v5 row_newbcast:6 row_mask:0xf bank_mask:0xf
v_and_b32_dpp v50, v20, v6 row_newbcast:6 row_mask:0xf bank_mask:0xf
v_and_b32_dpp v51, v20, v7 row_newbcast:6 row_mask:0xf bank_mask:0xf
v_mfma_f32_16x16x32_bf16 v[60:63], v[44:47], v[196:199], v[60:63]
v_and_b32_dpp v52, v20, v4 row_newbcast:7 row_mask:0xf bank_mask:0xf
v_and_b32_dpp v53, v20, v5 row_newbcast:7 row_mask:0xf bank_mask:0xf
v_and_b32_dpp v54, v20, v6 row_newbcast:7 row_mask:0xf bank_mask:0xf
v_and_b32_dpp v55, v20, v7 row_newbcast:7 row_mask:0xf bank_mask:0xf
v_mfma_f32_16x16x32_bf16 v[60:63], v[48:51], v[216:219], v[60:63]
s_nop 0
v_mfma_f32_16x16x32_bf16 v[60:63], v[52:55], v[236:239], v[60:63]
v_mfma_f32_16x16x32_bf16 v[64:67], v[24:27], v[100:103], 0
v_mfma_f32_16x16x32_bf16 v[64:67], v[28:31], v[120:123], v[64:67]
v_mfma_f32_16x16x32_bf16 v[64:67], v[32:35], v[140:143], v[64:67]
v_mfma_f32_16x16x32_bf16 v[64:67], v[36:39], v[160:163], v[64:67]
v_mfma_f32_16x16x32_bf16 v[64:67], v[40:43], v[180:183], v[64:67]
v_mfma_f32_16x16x32_bf16 v[64:67], v[44:47], v[200:203], v[64:67]
v_mfma_f32_16x16x32_bf16 v[64:67], v[48:51], v[220:223], v[64:67]
s_mov_b32 exec_hi, 0
ds_write_b128 v16, v[60:63] offset:14848
s_mov_b32 exec_hi, -1
v_mfma_f32_16x16x32_bf16 v[64:67], v[52:55], v[240:243], v[64:67]
v_mfma_f32_16x16x32_bf16 v[68:71], v[24:27], v[104:107], 0
v_mfma_f32_16x16x32_bf16 v[68:71], v[28:31], v[124:127], v[68:71]
v_mfma_f32_16x16x32_bf16 v[68:71], v[32:35], v[144:147], v[68:71]
v_mfma_f32_16x16x32_bf16 v[68:71], v[36:39], v[164:167], v[68:71]
v_mfma_f32_16x16x32_bf16 v[68:71], v[40:43], v[184:187], v[68:71]
v_mfma_f32_16x16x32_bf16 v[68:71], v[44:47], v[204:207], v[68:71]
v_mfma_f32_16x16x32_bf16 v[68:71], v[48:51], v[224:227], v[68:71]
s_mov_b32 exec_hi, 0
ds_write_b128 v16, v[64:67] offset:15360
s_mov_b32 exec_hi, -1
v_mfma_f32_16x16x32_bf16 v[68:71], v[52:55], v[244:247], v[68:71]
v_mfma_f32_16x16x32_bf16 v[72:75], v[24:27], v[108:111], 0
v_mfma_f32_16x16x32_bf16 v[72:75], v[28:31], v[128:131], v[72:75]
v_mfma_f32_16x16x32_bf16 v[72:75], v[32:35], v[148:151], v[72:75]
v_mfma_f32_16x16x32_bf16 v[72:75], v[36:39], v[168:171], v[72:75]
v_mfma_f32_16x16x32_bf16 v[72:75], v[40:43], v[188:191], v[72:75]
v_mfma_f32_16x16x32_bf16 v[72:75], v[44:47], v[208:211], v[72:75]
v_mfma_f32_16x16x32_bf16 v[72:75], v[48:51], v[228:231], v[72:75]
s_mov_b32 exec_hi, 0
ds_write_b128 v16, v[68:71] offset:15872
s_mov_b32 exec_hi, -1
v_mfma_f32_16x16x32_bf16 v[72:75], v[52:55], v[248:251], v[72:75]
v_mfma_f32_16x16x32_bf16 v[76:79], v[24:27], v[112:115], 0
v_mfma_f32_16x16x32_bf16 v[76:79], v[28:31], v[132:135], v[76:79]
v_mfma_f32_16x16x32_bf16 v[76:79], v[32:35], v[152:155], v[76:79]
v_mfma_f32_16x16x32_bf16 v[76:79], v[36:39], v[172:175], v[76:79]
v_mfma_f32_16x16x32_bf16 v[76:79], v[40:43], v[192:195], v[76:79]
v_mfma_f32_16x16x32_bf16 v[76:79], v[44:47], v[212:215], v[76:79]
v_mfma_f32_16x16x32_bf16 v[76:79], v[48:51], v[232:235], v[76:79]
s_mov_b32 exec_hi, 0
ds_write_b128 v16, v[72:75] offset:16384
s_mov_b32 exec_hi, -1
v_mfma_f32_16x16x32_bf16 v[76:79], v[52:55], v[252:255], v[76:79]
s_mov_b32 exec_hi, 0
s_nop 6
ds_write_b128 v16, v[76:79] offset:16896
s_mov_b32 exec_hi, -1
s_branch L_pub_go
L_pub_pre:
v_lshlrev_b32 v19, 4, v17
v_lshl_add_u32 v92, v17, 3, v57
s_mul_i32 s11, s8, 5120
s_add_u32 s11, s11, 262144
v_mov_b32 v89, s92
v_mov_b32 v91, s93
L_pub_go:
s_waitcnt lgkmcnt(0)
s_barrier
ds_read_b64 v[80:81], v92 offset:14848
ds_read_b64 v[82:83], v92 offset:17408
ds_read_b64 v[84:85], v92 offset:19968
ds_read_b64 v[86:87], v92 offset:22528
s_waitcnt lgkmcnt(0)
v_pk_add_f32 v[80:81], v[80:81], v[82:83]
v_pk_add_f32 v[84:85], v[84:85], v[86:87]
v_add_f32 v88, v80, v84
v_add_f32 v90, v81, v85
buffer_store_dwordx4 v[88:91], v19, s[56:59], s11 offen sc1
L_mlp:
v_lshlrev_b32 v74, 1, v0
v_mov_b32 v60, 0
v_mov_b32 v61, 0
v_mov_b32 v62, 0
v_mov_b32 v63, 0
v_mov_b32 v64, 0
v_mov_b32 v65, 0
v_mov_b32 v66, 0
v_mov_b32 v67, 0
v_mov_b32 v68, 0
v_mov_b32 v69, 0
v_mov_b32 v70, 0
v_mov_b32 v71, 0
ds_read_u16_d16_hi v60, v74 offset:512
ds_read_u16_d16_hi v61, v74 offset:1536
ds_read_u16_d16_hi v62, v74 offset:2560
ds_read_u16_d16_hi v63, v74 offset:3584
ds_read_u16_d16_hi v64, v74 offset:4608
ds_read_u16_d16_hi v65, v74 offset:5632
ds_read_u16_d16_hi v66, v74 offset:6656
ds_read_u16_d16_hi v67, v74 offset:7680
ds_read_u16_d16_hi v68, v74 offset:8704
ds_read_u16_d16_hi v69, v74 offset:9728
ds_read_u16_d16_hi v70, v74 offset:10752
ds_read_u16_d16_hi v71, v74 offset:11776
s_and_b32 s9, s2, 127
s_mul_i32 s9, s9, 20
v_lshl_add_u32 v74, v1, 2, s9
v_lshrrev_b32 v77, 1, v74
s_mul_i32 s9, s6, 1280
v_add_u32 v77, s9, v77
v_mov_b32 v72, 0xc0135761
v_mov_b32 v73, 1.0
v_and_b32 v75, 15, v1
v_lshrrev_b32 v76, 4, v1
s_lshl_b32 s9, s3, 4
v_lshl_add_u32 v76, v76, 2, s9
v_mul_u32_u24 v75, 144, v75
v_add_u32 v76, v75, v76
s_mov_b32 s44, 0xaaaaaaaa
s_mov_b32 s45, 0xaaaaaaaa
s_mov_b32 s46, 0xcccccccc
s_mov_b32 s47, 0xcccccccc
s_mov_b32 s48, 0x000f000f
s_mov_b32 s49, 0x000f000f
s_mov_b32 s60, s36
s_mov_b32 s61, s37
s_mov_b32 s62, 2560
s_mov_b32 s63, 0x20000
s_lshl_b32 s9, s26, 16
v_lshrrev_b32 v75, 3, v1
v_and_b32 v79, 7, v1
v_sub_u32 v77, v77, v1
v_sub_u32 v77, v77, v1
v_lshl_add_u32 v77, v75, 1, v77
v_lshlrev_b32 v224, 2, v1
v_sub_u32 v224, v74, v224
v_lshl_add_u32 v224, v75, 2, v224
v_mul_u32_u24 v75, 144, v75
v_lshl_add_u32 v75, v79, 4, v75
s_mov_b32 s50, 0xbdd2d3e8
s_mov_b32 s51, 0xbe9e1eee
s_waitcnt lgkmcnt(0)
v_pk_mul_f32 v[216:217], v[60:61], v[60:61]
v_pk_mul_f32 v[220:221], v[64:65], v[64:65]
v_pk_mul_f32 v[200:201], v[216:217], s[50:51] op_sel_hi:[1,0]
v_pk_mul_f32 v[204:205], v[216:217], s[50:51] op_sel:[0,1] op_sel_hi:[1,1]
v_pk_fma_f32 v[208:209], v[220:221], s[50:51], v[72:73] op_sel:[0,1,0] op_sel_hi:[1,1,0]
v_pk_fma_f32 v[212:213], v[220:221], s[50:51], v[72:73] op_sel_hi:[1,0,0]
v_pk_mul_f32 v[200:201], v[200:201], v[60:61]
v_pk_mul_f32 v[204:205], v[204:205], v[64:65]
v_pk_mul_f32 v[208:209], v[208:209], v[60:61]
v_pk_mul_f32 v[212:213], v[212:213], v[64:65]
v_pk_mul_f32 v[216:217], v[60:61], v[68:69]
v_pk_mul_f32 v[220:221], v[64:65], v[68:69]
v_pk_mul_f32 v[218:219], v[62:63], v[62:63]
v_pk_mul_f32 v[222:223], v[66:67], v[66:67]
v_pk_mul_f32 v[202:203], v[218:219], s[50:51] op_sel_hi:[1,0]
v_pk_mul_f32 v[206:207], v[218:219], s[50:51] op_sel:[0,1] op_sel_hi:[1,1]
v_pk_fma_f32 v[210:211], v[222:223], s[50:51], v[72:73] op_sel:[0,1,0] op_sel_hi:[1,1,0]
v_pk_fma_f32 v[214:215], v[222:223], s[50:51], v[72:73] op_sel_hi:[1,0,0]
v_pk_mul_f32 v[202:203], v[202:203], v[62:63]
v_pk_mul_f32 v[206:207], v[206:207], v[66:67]
v_pk_mul_f32 v[210:211], v[210:211], v[62:63]
v_pk_mul_f32 v[214:215], v[214:215], v[66:67]
v_pk_mul_f32 v[218:219], v[62:63], v[70:71]
v_pk_mul_f32 v[222:223], v[66:67], v[70:71]
L_mlp_b:
s_mov_b32 s42, 0xbdd2d3e8
s_waitcnt lgkmcnt(0)
s_barrier
ds_read_b32 v78, v74 offset:25088
ds_read_b64 v[20:21], v57 offset:27648
ds_read_b32 v79, v224 offset:25088
s_waitcnt lgkmcnt(1)
v_sub_f32 v20, v78, v20
v_mul_f32 v20, v20, v21
s_nop 0
v_readlane_b32 s96, v20, 0
v_readlane_b32 s98, v20, 1
v_readlane_b32 s100, v20, 2
v_readlane_b32 s10, v20, 3
v_readlane_b32 s12, v20, 4
s_nop 0
v_pk_fma_f32 v[20:21], s[96:97], v[200:201], v[204:205] op_sel_hi:[0,1,1]
v_pk_fma_f32 v[22:23], s[96:97], v[202:203], v[206:207] op_sel_hi:[0,1,1]
v_pk_fma_f32 v[20:21], s[96:97], v[20:21], v[208:209] op_sel_hi:[0,1,1]
v_pk_fma_f32 v[22:23], s[96:97], v[22:23], v[210:211] op_sel_hi:[0,1,1]
v_pk_fma_f32 v[20:21], s[96:97], v[20:21], v[212:213] op_sel_hi:[0,1,1]
v_pk_fma_f32 v[22:23], s[96:97], v[22:23], v[214:215] op_sel_hi:[0,1,1]
v_exp_f32 v20, v20
v_exp_f32 v21, v21
v_exp_f32 v22, v22
v_exp_f32 v23, v23
v_pk_fma_f32 v[16:17], s[96:97], v[216:217], v[220:221] op_sel_hi:[0,1,1]
v_pk_fma_f32 v[18:19], s[96:97], v[218:219], v[222:223] op_sel_hi:[0,1,1]
v_pk_add_f32 v[20:21], v[20:21], v[72:73] op_sel:[0,1] op_sel_hi:[1,1]
v_pk_add_f32 v[22:23], v[22:23], v[72:73] op_sel:[0,1] op_sel_hi:[1,1]
v_rcp_f32 v20, v20
v_rcp_f32 v21, v21
v_rcp_f32 v22, v22
v_rcp_f32 v23, v23
s_nop 0
v_pk_mul_f32 v[24:25], v[16:17], v[20:21]
v_pk_fma_f32 v[24:25], v[18:19], v[22:23], v[24:25]
v_pk_fma_f32 v[20:21], s[98:99], v[200:201], v[204:205] op_sel_hi:[0,1,1]
v_pk_fma_f32 v[22:23], s[98:99], v[202:203], v[206:207] op_sel_hi:[0,1,1]
v_pk_fma_f32 v[20:21], s[98:99], v[20:21], v[208:209] op_sel_hi:[0,1,1]
v_pk_fma_f32 v[22:23], s[98:99], v[22:23], v[210:211] op_sel_hi:[0,1,1]
v_pk_fma_f32 v[20:21], s[98:99], v[20:21], v[212:213] op_sel_hi:[0,1,1]
v_pk_fma_f32 v[22:23], s[98:99], v[22:23], v[214:215] op_sel_hi:[0,1,1]
v_exp_f32 v20, v20
v_exp_f32 v21, v21
v_exp_f32 v22, v22
v_exp_f32 v23, v23
v_pk_fma_f32 v[16:17], s[98:99], v[216:217], v[220:221] op_sel_hi:[0,1,1]
v_pk_fma_f32 v[18:19], s[98:99], v[218:219], v[222:223] op_sel_hi:[0,1,1]
v_pk_add_f32 v[20:21], v[20:21], v[72:73] op_sel:[0,1] op_sel_hi:[1,1]
v_pk_add_f32 v[22:23], v[22:23], v[72:73] op_sel:[0,1] op_sel_hi:[1,1]
v_rcp_f32 v20, v20
v_rcp_f32 v21, v21
v_rcp_f32 v22, v22
v_rcp_f32 v23, v23
s_nop 0
v_pk_mul_f32 v[26:27], v[16:17], v[20:21]
v_pk_fma_f32 v[26:27], v[18:19], v[22:23], v[26:27]
v_pk_fma_f32 v[20:21], s[100:101], v[200:201], v[204:205] op_sel_hi:[0,1,1]
v_pk_fma_f32 v[22:23], s[100:101], v[202:203], v[206:207] op_sel_hi:[0,1,1]
v_pk_fma_f32 v[20:21], s[100:101], v[20:21], v[208:209] op_sel_hi:[0,1,1]
v_pk_fma_f32 v[22:23], s[100:101], v[22:23], v[210:211] op_sel_hi:[0,1,1]
v_pk_fma_f32 v[20:21], s[100:101], v[20:21], v[212:213] op_sel_hi:[0,1,1]
v_pk_fma_f32 v[22:23], s[100:101], v[22:23], v[214:215] op_sel_hi:[0,1,1]
v_exp_f32 v20, v20
v_exp_f32 v21, v21
v_exp_f32 v22, v22
v_exp_f32 v23, v23
v_pk_fma_f32 v[16:17], s[100:101], v[216:217], v[220:221] op_sel_hi:[0,1,1]
v_pk_fma_f32 v[18:19], s[100:101], v[218:219], v[222:223] op_sel_hi:[0,1,1]
v_pk_add_f32 v[20:21], v[20:21], v[72:73] op_sel:[0,1] op_sel_hi:[1,1]
v_pk_add_f32 v[22:23], v[22:23], v[72:73] op_sel:[0,1] op_sel_hi:[1,1]
v_rcp_f32 v20, v20
v_rcp_f32 v21, v21
v_rcp_f32 v22, v22
v_rcp_f32 v23, v23
s_nop 0
v_pk_mul_f32 v[28:29], v[16:17], v[20:21]
v_pk_fma_f32 v[28:29], v[18:19], v[22:23], v[28:29]
v_pk_fma_f32 v[20:21], s[10:11], v[200:201], v[204:205] op_sel_hi:[0,1,1]
v_pk_fma_f32 v[22:23], s[10:11], v[202:203], v[206:207] op_sel_hi:[0,1,1]
v_pk_fma_f32 v[20:21], s[10:11], v[20:21], v[208:209] op_sel_hi:[0,1,1]
v_pk_fma_f32 v[22:23], s[10:11], v[22:23], v[210:211] op_sel_hi:[0,1,1]
v_pk_fma_f32 v[20:21], s[10:11], v[20:21], v[212:213] op_sel_hi:[0,1,1]
v_pk_fma_f32 v[22:23], s[10:11], v[22:23], v[214:215] op_sel_hi:[0,1,1]
v_exp_f32 v20, v20
v_exp_f32 v21, v21
v_exp_f32 v22, v22
v_exp_f32 v23, v23
v_pk_fma_f32 v[16:17], s[10:11], v[216:217], v[220:221] op_sel_hi:[0,1,1]
v_pk_fma_f32 v[18:19], s[10:11], v[218:219], v[222:223] op_sel_hi:[0,1,1]
v_pk_add_f32 v[20:21], v[20:21], v[72:73] op_sel:[0,1] op_sel_hi:[1,1]
v_pk_add_f32 v[22:23], v[22:23], v[72:73] op_sel:[0,1] op_sel_hi:[1,1]
v_rcp_f32 v20, v20
v_rcp_f32 v21, v21
v_rcp_f32 v22, v22
v_rcp_f32 v23, v23
s_nop 0
v_pk_mul_f32 v[30:31], v[16:17], v[20:21]
v_pk_fma_f32 v[30:31], v[18:19], v[22:23], v[30:31]
v_pk_fma_f32 v[20:21], s[12:13], v[200:201], v[204:205] op_sel_hi:[0,1,1]
v_pk_fma_f32 v[22:23], s[12:13], v[202:203], v[206:207] op_sel_hi:[0,1,1]
v_pk_fma_f32 v[20:21], s[12:13], v[20:21], v[208:209] op_sel_hi:[0,1,1]
v_pk_fma_f32 v[22:23], s[12:13], v[22:23], v[210:211] op_sel_hi:[0,1,1]
v_pk_fma_f32 v[20:21], s[12:13], v[20:21], v[212:213] op_sel_hi:[0,1,1]
v_pk_fma_f32 v[22:23], s[12:13], v[22:23], v[214:215] op_sel_hi:[0,1,1]
v_exp_f32 v20, v20
v_exp_f32 v21, v21
v_exp_f32 v22, v22
v_exp_f32 v23, v23
v_pk_fma_f32 v[16:17], s[12:13], v[216:217], v[220:221] op_sel_hi:[0,1,1]
v_pk_fma_f32 v[18:19], s[12:13], v[218:219], v[222:223] op_sel_hi:[0,1,1]
v_pk_add_f32 v[20:21], v[20:21], v[72:73] op_sel:[0,1] op_sel_hi:[1,1]
v_pk_add_f32 v[22:23], v[22:23], v[72:73] op_sel:[0,1] op_sel_hi:[1,1]
v_rcp_f32 v20, v20
v_rcp_f32 v21, v21
v_rcp_f32 v22, v22
v_rcp_f32 v23, v23
s_nop 0
v_pk_mul_f32 v[32:33], v[16:17], v[20:21]
v_pk_fma_f32 v[32:33], v[18:19], v[22:23], v[32:33]
v_add_f32 v24, v24, v25
v_add_f32 v26, v26, v27
v_add_f32 v28, v28, v29
v_add_f32 v30, v30, v31
v_add_f32 v32, v32, v33
v_add_f32_dpp v24, v24, v24 quad_perm:[1,0,3,2] row_mask:0xf bank_mask:0xf
v_add_f32_dpp v26, v26, v26 quad_perm:[1,0,3,2] row_mask:0xf bank_mask:0xf
v_add_f32_dpp v28, v28, v28 quad_perm:[1,0,3,2] row_mask:0xf bank_mask:0xf
v_add_f32_dpp v30, v30, v30 quad_perm:[1,0,3,2] row_mask:0xf bank_mask:0xf
v_add_f32_dpp v32, v32, v32 quad_perm:[1,0,3,2] row_mask:0xf bank_mask:0xf
v_add_f32_dpp v24, v24, v24 quad_perm:[2,3,0,1] row_mask:0xf bank_mask:0xf
v_add_f32_dpp v26, v26, v26 quad_perm:[2,3,0,1] row_mask:0xf bank_mask:0xf
v_add_f32_dpp v28, v28, v28 quad_perm:[2,3,0,1] row_mask:0xf bank_mask:0xf
v_add_f32_dpp v30, v30, v30 quad_perm:[2,3,0,1] row_mask:0xf bank_mask:0xf
v_add_f32_dpp v32, v32, v32 quad_perm:[2,3,0,1] row_mask:0xf bank_mask:0xf
v_cndmask_b32 v25, v24, v26, s[44:45]
v_cndmask_b32 v27, v28, v30, s[44:45]
v_cndmask_b32 v24, v25, v27, s[46:47]
s_nop 0
v_add_f32_dpp v32, v32, v32 row_ror:4 row_mask:0xf bank_mask:0xf
v_add_f32_dpp v24, v24, v24 row_ror:4 row_mask:0xf bank_mask:0xf
s_nop 0
v_add_f32_dpp v32, v32, v32 row_ror:8 row_mask:0xf bank_mask:0xf
v_add_f32_dpp v24, v24, v24 row_ror:8 row_mask:0xf bank_mask:0xf
s_nop 0
v_cndmask_b32 v24, v32, v24, s[48:49]
ds_write_b32 v76, v24 offset:27712
s_waitcnt lgkmcnt(0)
s_barrier
s_cmp_lg_u32 s3, 0
s_cbranch_scc1 L_fin
ds_read_b128 v[96:99], v75 offset:27712
s_waitcnt lgkmcnt(0)
v_pk_add_f32 v[96:97], v[96:97], v[98:99]
v_add_f32 v18, v96, v97
s_nop 1
v_add_f32_dpp v18, v18, v18 quad_perm:[1,0,3,2] row_mask:0xf bank_mask:0xf
s_nop 1
v_add_f32_dpp v18, v18, v18 quad_perm:[2,3,0,1] row_mask:0xf bank_mask:0xf
s_nop 1
v_add_f32_dpp v18, v18, v18 row_half_mirror row_mask:0xf bank_mask:0xf
v_cvt_pk_bf16_f32 v18, 0, v18
v_add_f32 v18, s9, v18
v_cvt_pk_bf16_f32 v18, 0, v18
v_add_f32 v18, v79, v18
v_cvt_pk_bf16_f32 v18, v18, v18
s_mov_b32 exec_lo, 0x01010101
s_mov_b32 exec_hi, 1
buffer_store_short v18, v77, s[60:63], 0 offen
s_mov_b64 exec, -1
L_fin:
L_end:
s_endpgm
.section .rodata,"a"
.p2align 6
.amdhsa_kernel sequential_preLN__mha_block_cached__mixer_token_mlp__decode_kernel
  .amdhsa_next_free_vgpr 256
  .amdhsa_next_free_sgpr 102
  .amdhsa_accum_offset 256
  .amdhsa_group_segment_fixed_size 0
  .amdhsa_kernarg_size 104
  .amdhsa_user_sgpr_count 2
  .amdhsa_user_sgpr_kernarg_segment_ptr 1
  .amdhsa_system_sgpr_workgroup_id_x 1
  .amdhsa_float_denorm_mode_32 3
  .amdhsa_float_denorm_mode_16_64 3
.end_amdhsa_kernel
```
